```python
import torch

def _softmax(x, axis=-1):
    return torch.softmax(x, dim=axis)
def _gelu(x):
    return torch.nn.functional.gelu(x, approximate="tanh")
def _silu(x):
    return torch.nn.functional.silu(x)
def _sigmoid(x):
    return torch.sigmoid(x)
def _layernorm(x, axis=-1, eps=1e-5):
    m = x.mean(dim=axis, keepdim=True)
    v = x.var(dim=axis, keepdim=True, unbiased=False)
    return (x - m) / torch.sqrt(v + eps)
def _scatter_add(tgt, idx, src, axis=0):
    return tgt.clone().index_add_(axis, idx, src)
def _segment_sum(src, seg, n):
    out = torch.zeros((n,) + src.shape[1:], dtype=src.dtype)
    return out.index_add_(0, seg, src)
def _pad(x, pw):
    flat = tuple(v for pair in reversed(pw) for v in pair)
    return torch.nn.functional.pad(x, flat)

kernel_name = 'recurrent_scan__mha_block_cached__swiglu_ffn__decode'

def setup_inputs():

    _w = (lambda a: (lambda t: t.to(torch.bfloat16) if t.is_floating_point() else t)(torch.as_tensor(a)))
    def _A_setup():
        B, Sq, D = 4, 1, 512
        H, Sk, Dh = 32, 8192, 128
        return {
            "x": _w((lambda *s: torch.randn(*s, dtype=torch.bfloat16) * 0.05)(B, Sq, D)),
            "k_cache": _w((lambda *s: torch.randn(*s, dtype=torch.bfloat16) * 1.6)(B, H, Sk, Dh)),
            "v_cache": _w((lambda *s: torch.randn(*s, dtype=torch.bfloat16) * 0.2)(B, H, Sk, Dh)),
            "wq": _w((lambda *s: torch.randn(*s, dtype=torch.bfloat16) * 1.6)(D, H * Dh) * (D ** -0.5)),
            "wo": _w((lambda *s: torch.randn(*s, dtype=torch.bfloat16) * 0.2)(H * Dh, D) * ((H * Dh) ** -0.5)),
        }
    _A_in = _A_setup()

    def _B_setup():
        B, S, D, F = 4, 1, 512, 1792
        return {
            "x": _w((lambda *s: torch.randn(*s, dtype=torch.bfloat16) * 0.05)(B, S, D)),
            "w_gate": _w((lambda *s: torch.randn(*s, dtype=torch.bfloat16) * 0.1)(D, F)),
            "w_up": _w((lambda *s: torch.randn(*s, dtype=torch.bfloat16) * 0.1)(D, F)),
            "w_down": _w((lambda *s: torch.randn(*s, dtype=torch.bfloat16) * 0.1)(F, D)),
        }
    _B_in = _B_setup()

    return {
        "A_x": _A_in["x"],
        "A_k_cache": _A_in["k_cache"],
        "A_v_cache": _A_in["v_cache"],
        "A_wq": _A_in["wq"],
        "A_wo": _A_in["wo"],
        "B_x": _B_in["x"],
        "B_w_gate": _B_in["w_gate"],
        "B_w_up": _B_in["w_up"],
        "B_w_down": _B_in["w_down"],
    }

def reference(A_x, A_k_cache, A_v_cache, A_wq, A_wo, B_x, B_w_gate, B_w_up, B_w_down):
    def _A_ref(x, k_cache, v_cache, wq, wo):
        B, Sq, D = x.shape
        H, Dh = 32, 128
        q = (lambda x, *d: x.permute(*d))((x @ wq).reshape(B, Sq, H, Dh), 0, 2, 1, 3)
        scores = torch.einsum("bhqd,bhkd->bhqk", q, k_cache) * (Dh ** -0.5)
        p = _softmax(scores, axis=-1)
        o = torch.einsum("bhqk,bhkd->bhqd", p, v_cache)
        return (lambda x, *d: x.permute(*d))(o, 0, 2, 1, 3).reshape(B, Sq, H * Dh) @ wo

    def _B_ref(x, w_gate, w_up, w_down):
        g = _silu(x @ w_gate)
        u = x @ w_up
        return (g * u) @ w_down

    x = A_x
    xn = _layernorm(x, axis=-1)
    s = _A_ref(xn, A_k_cache, A_v_cache, A_wq, A_wo)
    g = _silu(_B_ref(xn, B_w_gate, B_w_up, B_w_down))
    return x + s * g
```

```asm
; @launch grid=(256,1,1) block=(512,1,1) lds=115712
.amdgcn_target "amdgcn-amd-amdhsa--gfx950"
.text
.globl recurrent_scan__mha_block_cached__swiglu_ffn__decode_kernel
.p2align 8
.type recurrent_scan__mha_block_cached__swiglu_ffn__decode_kernel,@function
recurrent_scan__mha_block_cached__swiglu_ffn__decode_kernel:
  s_cmp_ge_u32 s2, 256
  s_cbranch_scc1 L_end
  s_load_dwordx16 s[36:51], s[0:1], 0
  s_load_dwordx8 s[52:59], s[0:1], 64
  v_lshrrev_b32 v10, 6, v0
  v_and_b32 v1, 63, v0
  v_readfirstlane_b32 s3, v10
  s_and_b32 s4, s2, 127
  s_lshr_b32 s6, s2, 7
  s_lshl_b32 s7, s4, 21
  s_and_b32 s64, s4, 31
  s_lshr_b32 s65, s4, 5
  s_lshl_b32 s69, s65, 1
  s_add_u32 s69, s69, s6
  s_lshl_b32 s66, s4, 1
  s_add_u32 s66, s66, s6
  s_cmp_ge_u32 s3, 4
  s_cbranch_scc1 L_helper
  v_lshlrev_b32 v10, 12, v10
  s_lshl_b32 s6, s6, 14
  v_add_u32 v10, s6, v10
  v_lshl_add_u32 v3, v1, 4, v10
  s_lshr_b32 s16, s2, 3
  s_mul_i32 s16, s16, 65536
  s_and_b32 s16, s16, 2097151
  s_waitcnt lgkmcnt(0)
  s_add_u32 s8, s38, s7
  s_addc_u32 s9, s39, 0
  s_mov_b32 s10, 2097152
  s_mov_b32 s11, 0x00020000
  s_add_u32 s12, s40, s7
  s_addc_u32 s13, s41, 0
  s_mov_b32 s14, 2097152
  s_mov_b32 s15, 0x00020000
  s_lshl_b32 s5, s3, 14
  s_add_u32 s74, s5, 50176
  s_mov_b32 m0, s74
  s_mov_b32 s18, s16
  buffer_load_dwordx4 v3, s[8:11], s18 offen offset:0 nt lds
  buffer_load_dwordx4 v3, s[8:11], s18 offen offset:1024 nt lds
  buffer_load_dwordx4 v3, s[8:11], s18 offen offset:2048 nt lds
  buffer_load_dwordx4 v3, s[8:11], s18 offen offset:3072 nt lds
  s_add_u32 s18, s18, 32768
  s_and_b32 s18, s18, 2097151
  s_add_u32 m0, m0, 4096
  s_nop 0
  buffer_load_dwordx4 v3, s[8:11], s18 offen offset:0 nt lds
  v_and_b32 v13, 1, v1
  v_lshlrev_b32 v13, 4, v13
  v_mov_b32 v14, 0xffff
  v_lshlrev_b32 v14, v13, v14
  v_bfe_u32 v13, v1, 1, 2
  v_cmp_eq_u32 vcc, 0, v13
  s_nop 1
  v_cndmask_b32 v4, 0, v14, vcc
  v_cmp_eq_u32 vcc, 1, v13
  s_nop 1
  v_cndmask_b32 v5, 0, v14, vcc
  v_cmp_eq_u32 vcc, 2, v13
  s_nop 1
  v_cndmask_b32 v6, 0, v14, vcc
  v_cmp_eq_u32 vcc, 3, v13
  s_nop 1
  v_cndmask_b32 v7, 0, v14, vcc
  v_and_b32 v11, 15, v1
  v_lshrrev_b32 v12, 4, v1
  v_and_b32 v13, 1, v12
  v_lshlrev_b32 v13, 4, v13
  v_lshl_add_u32 v60, v11, 5, v13
  s_mov_b32 s70, 0x3fb8aa3b
  s_mov_b32 s71, 0x3db504f3
  s_waitcnt vmcnt(4)
  buffer_load_dwordx4 v3, s[8:11], s18 offen offset:1024 nt lds
  s_waitcnt vmcnt(4)
  buffer_load_dwordx4 v3, s[8:11], s18 offen offset:2048 nt lds
  s_waitcnt vmcnt(4)
  buffer_load_dwordx4 v3, s[8:11], s18 offen offset:3072 nt lds
  s_waitcnt vmcnt(4)
  s_add_u32 s18, s18, 32768
  s_and_b32 s18, s18, 2097151
  s_add_u32 m0, m0, 4096
  s_nop 0
  buffer_load_dwordx4 v3, s[8:11], s18 offen offset:0 nt lds
  s_waitcnt vmcnt(4)
  buffer_load_dwordx4 v3, s[8:11], s18 offen offset:1024 nt lds
  s_waitcnt vmcnt(4)
  buffer_load_dwordx4 v3, s[8:11], s18 offen offset:2048 nt lds
  s_waitcnt vmcnt(4)
  buffer_load_dwordx4 v3, s[8:11], s18 offen offset:3072 nt lds
  s_waitcnt vmcnt(4)
  s_add_u32 s18, s18, 32768
  s_and_b32 s18, s18, 2097151
  s_add_u32 m0, m0, 4096
  s_nop 0
  buffer_load_dwordx4 v3, s[8:11], s18 offen offset:0 nt lds
  s_waitcnt vmcnt(4)
  buffer_load_dwordx4 v3, s[8:11], s18 offen offset:1024 nt lds
  s_waitcnt vmcnt(4)
  buffer_load_dwordx4 v3, s[8:11], s18 offen offset:2048 nt lds
  s_waitcnt vmcnt(4)
  buffer_load_dwordx4 v3, s[8:11], s18 offen offset:3072 nt lds
  s_add_u32 s16, s18, 32768
  s_and_b32 s16, s16, 2097151
  s_waitcnt vmcnt(4)
  buffer_load_dwordx4 v[64:67], v3, s[8:11], s16 offen offset:0 nt
  s_waitcnt vmcnt(4)
  buffer_load_dwordx4 v[68:71], v3, s[8:11], s16 offen offset:1024 nt
  s_waitcnt vmcnt(4)
  buffer_load_dwordx4 v[72:75], v3, s[8:11], s16 offen offset:2048 nt
  s_waitcnt vmcnt(4)
  buffer_load_dwordx4 v[76:79], v3, s[8:11], s16 offen offset:3072 nt
  s_waitcnt vmcnt(4)
  s_add_u32 s16, s16, 32768
  s_and_b32 s16, s16, 2097151
  buffer_load_dwordx4 v[80:83], v3, s[8:11], s16 offen offset:0 nt
  v_mov_b32 v8, 0xff800000
  v_mov_b32 v36, 0
  v_mov_b32 v37, 0
  v_mov_b32 v38, 0
  v_mov_b32 v39, 0
  v_lshlrev_b32 v15, 5, v11
  s_waitcnt vmcnt(4)
  buffer_load_dwordx4 v[84:87], v3, s[8:11], s16 offen offset:1024 nt
  s_mul_i32 s4, s3, 272
  v_lshrrev_b32 v57, 1, v60
  v_add_u32 v57, s4, v57
  s_lshl_b32 s5, s3, 2
  v_mov_b32 v58, s5
  v_and_b32 v9, 60, v1
  s_waitcnt vmcnt(4)
  buffer_load_dwordx4 v[88:91], v3, s[8:11], s16 offen offset:2048 nt
  s_lshl_b32 s5, s3, 12
  v_add_u32 v9, s5, v9
  v_mov_b32 v12, v9
  v_add_u32 v9, 256, v9
  s_mov_b32 s28, s56
  s_mov_b32 s29, s57
  s_waitcnt vmcnt(4)
  buffer_load_dwordx4 v[92:95], v3, s[8:11], s16 offen offset:3072 nt
  s_mov_b32 s30, 256
  s_mov_b32 s31, 0x00020000
  s_mov_b32 s60, s58
  s_mov_b32 s61, s59
  s_mov_b32 s62, 4194304
  s_mov_b32 s63, 0x00020000
  s_waitcnt vmcnt(4)
  s_add_u32 s16, s16, 32768
  s_and_b32 s16, s16, 2097151
  buffer_load_dwordx4 v[96:99], v3, s[8:11], s16 offen offset:0 nt
  s_add_u32 s20, s58, 1048576
  s_addc_u32 s21, s59, 0
  s_mov_b32 s22, 229376
  s_mov_b32 s23, 0x00020000
  s_mov_b32 s24, s54
  s_mov_b32 s25, s55
  s_waitcnt vmcnt(4)
  buffer_load_dwordx4 v[100:103], v3, s[8:11], s16 offen offset:1024 nt
  s_mov_b32 s26, 4096
  s_mov_b32 s27, 0x00020000
  s_mov_b32 s32, s36
  s_mov_b32 s33, s37
  s_mov_b32 s34, 4096
  s_mov_b32 s35, 0x00020000
  s_waitcnt vmcnt(4)
  buffer_load_dwordx4 v[104:107], v3, s[8:11], s16 offen offset:2048 nt
  v_cmp_eq_u32 vcc, s65, v0
  s_nop 1
  v_cndmask_b32 v62, 0, 1, vcc
  s_cmp_lt_u32 s2, 28
  s_cselect_b32 s72, 0x10000, 0
  v_add_u32 v62, s72, v62
  v_lshlrev_b32 v61, 6, v0
  s_waitcnt vmcnt(4)
  buffer_load_dwordx4 v[108:111], v3, s[8:11], s16 offen offset:3072 nt
  v_mov_b32 v63, 0x1000
  v_cmp_ne_u32 vcc, 0, v62
  s_nop 1
  v_cndmask_b32 v61, v63, v61, vcc
  s_add_u32 s72, s72, 1
  v_lshrrev_b32 v2, 2, v1
  v_and_b32 v63, 3, v1
  s_waitcnt vmcnt(4)
  s_add_u32 s16, s16, 32768
  s_and_b32 s16, s16, 2097151
  buffer_load_dwordx4 v[112:115], v3, s[8:11], s16 offen offset:0 nt
  v_lshlrev_b32 v56, 4, v63
  s_mul_i32 s68, s65, 131072
  s_lshl_b32 s73, s65, 9
  s_add_u32 s73, s73, 524288
  s_lshl_b32 s67, s65, 10
  s_lshl_b32 s7, s3, 6
  s_waitcnt vmcnt(4)
  buffer_load_dwordx4 v[116:119], v3, s[8:11], s16 offen offset:1024 nt
  s_add_u32 s67, s67, s7
  s_lshl_b32 s7, s3, 6
  s_add_u32 s68, s68, s7
  v_mov_b32 v59, 0
  s_waitcnt vmcnt(4)
  buffer_load_dwordx4 v[120:123], v3, s[8:11], s16 offen offset:2048 nt
  s_waitcnt vmcnt(4)
  buffer_load_dwordx4 v[124:127], v3, s[8:11], s16 offen offset:3072 nt
  s_waitcnt vmcnt(4)
  s_add_u32 s16, s16, 32768
  s_and_b32 s16, s16, 2097151
  buffer_load_dwordx4 v[128:131], v3, s[8:11], s16 offen offset:0 nt
  s_waitcnt vmcnt(4)
  buffer_load_dwordx4 v[132:135], v3, s[8:11], s16 offen offset:1024 nt
  s_waitcnt vmcnt(4)
  buffer_load_dwordx4 v[136:139], v3, s[8:11], s16 offen offset:2048 nt
  s_waitcnt vmcnt(4)
  buffer_load_dwordx4 v[140:143], v3, s[8:11], s16 offen offset:3072 nt
  s_waitcnt vmcnt(4)
  s_add_u32 s16, s16, 32768
  s_and_b32 s16, s16, 2097151
  buffer_load_dwordx4 v[144:147], v3, s[8:11], s16 offen offset:0 nt
  s_waitcnt vmcnt(4)
  buffer_load_dwordx4 v[148:151], v3, s[8:11], s16 offen offset:1024 nt
  s_waitcnt vmcnt(4)
  buffer_load_dwordx4 v[152:155], v3, s[8:11], s16 offen offset:2048 nt
  s_waitcnt vmcnt(4)
  buffer_load_dwordx4 v[156:159], v3, s[8:11], s16 offen offset:3072 nt
  s_waitcnt vmcnt(4)
  s_add_u32 s16, s16, 32768
  s_and_b32 s16, s16, 2097151
  buffer_load_dwordx4 v[160:163], v3, s[8:11], s16 offen offset:0 nt
  s_waitcnt vmcnt(4)
  buffer_load_dwordx4 v[164:167], v3, s[8:11], s16 offen offset:1024 nt
  s_waitcnt vmcnt(4)
  buffer_load_dwordx4 v[168:171], v3, s[8:11], s16 offen offset:2048 nt
  s_waitcnt vmcnt(4)
  buffer_load_dwordx4 v[172:175], v3, s[8:11], s16 offen offset:3072 nt
  s_waitcnt vmcnt(4)
  s_add_u32 s16, s16, 32768
  s_and_b32 s16, s16, 2097151
  buffer_load_dwordx4 v[176:179], v3, s[8:11], s16 offen offset:0 nt
  s_waitcnt vmcnt(4)
  buffer_load_dwordx4 v[180:183], v3, s[8:11], s16 offen offset:1024 nt
  s_waitcnt vmcnt(4)
  buffer_load_dwordx4 v[184:187], v3, s[8:11], s16 offen offset:2048 nt
  s_waitcnt vmcnt(4)
  buffer_load_dwordx4 v[188:191], v3, s[8:11], s16 offen offset:3072 nt
  s_waitcnt vmcnt(4)
  s_add_u32 s16, s16, 32768
  s_and_b32 s16, s16, 2097151
  buffer_load_dwordx4 v[192:195], v3, s[8:11], s16 offen offset:0 nt
  s_waitcnt vmcnt(4)
  buffer_load_dwordx4 v[196:199], v3, s[8:11], s16 offen offset:1024 nt
  s_waitcnt vmcnt(4)
  buffer_load_dwordx4 v[200:203], v3, s[8:11], s16 offen offset:2048 nt
  s_waitcnt vmcnt(4)
  buffer_load_dwordx4 v[204:207], v3, s[8:11], s16 offen offset:3072 nt
  s_waitcnt vmcnt(4)
  s_add_u32 s16, s16, 32768
  s_and_b32 s16, s16, 2097151
  buffer_load_dwordx4 v[208:211], v3, s[8:11], s16 offen offset:0 nt
  s_waitcnt vmcnt(4)
  buffer_load_dwordx4 v[212:215], v3, s[8:11], s16 offen offset:1024 nt
  s_waitcnt vmcnt(4)
  buffer_load_dwordx4 v[216:219], v3, s[8:11], s16 offen offset:2048 nt
  s_waitcnt vmcnt(4)
  buffer_load_dwordx4 v[220:223], v3, s[8:11], s16 offen offset:3072 nt
  s_waitcnt vmcnt(4)
  s_add_u32 s16, s16, 32768
  s_and_b32 s16, s16, 2097151
  buffer_load_dwordx4 v[224:227], v3, s[8:11], s16 offen offset:0 nt
  s_waitcnt vmcnt(4)
  buffer_load_dwordx4 v[228:231], v3, s[8:11], s16 offen offset:1024 nt
  s_waitcnt vmcnt(4)
  buffer_load_dwordx4 v[232:235], v3, s[8:11], s16 offen offset:2048 nt
  s_waitcnt vmcnt(4)
  buffer_load_dwordx4 v[236:239], v3, s[8:11], s16 offen offset:3072 nt
  s_waitcnt vmcnt(4)
  s_add_u32 s16, s16, 32768
  s_and_b32 s16, s16, 2097151
  buffer_load_dwordx4 v[240:243], v3, s[8:11], s16 offen offset:0 nt
  s_barrier
  ds_read_b128 v[40:43], v15 offset:16384
  ds_read_b128 v[44:47], v15 offset:16400
  ds_read_b128 v[48:51], v15 offset:16896
  ds_read_b128 v[52:55], v15 offset:16912
  ds_read_b128 v[20:23], v15 offset:17408
  ds_read_b128 v[24:27], v15 offset:17424
  ds_read_b128 v[28:31], v15 offset:17920
  ds_read_b128 v[32:35], v15 offset:17936
  s_waitcnt vmcnt(4)
  buffer_load_dwordx4 v[244:247], v3, s[8:11], s16 offen offset:1024 nt
  s_waitcnt lgkmcnt(0)
  v_add_f32 v40, v40, v48
  v_add_f32 v20, v20, v28
  v_add_f32 v41, v41, v49
  v_add_f32 v21, v21, v29
  v_add_f32 v42, v42, v50
  v_add_f32 v22, v22, v30
  v_add_f32 v43, v43, v51
  v_add_f32 v23, v23, v31
  v_add_f32 v44, v44, v52
  v_add_f32 v24, v24, v32
  v_add_f32 v45, v45, v53
  v_add_f32 v25, v25, v33
  v_add_f32 v46, v46, v54
  v_add_f32 v26, v26, v34
  v_add_f32 v47, v47, v55
  v_add_f32 v27, v27, v35
  v_add_f32 v40, v40, v20
  v_add_f32 v41, v41, v21
  v_add_f32 v42, v42, v22
  v_add_f32 v43, v43, v23
  v_add_f32 v44, v44, v24
  v_add_f32 v45, v45, v25
  v_add_f32 v46, v46, v26
  v_add_f32 v47, v47, v27
  v_cvt_pk_bf16_f32 v16, v40, v41
  v_cvt_pk_bf16_f32 v17, v42, v43
  v_cvt_pk_bf16_f32 v18, v44, v45
  v_cvt_pk_bf16_f32 v19, v46, v47
  s_waitcnt vmcnt(4)
  buffer_load_dwordx4 v[248:251], v3, s[8:11], s16 offen offset:2048 nt
  v_dot2_f32_bf16 v32, v64, v16, 0
  v_dot2_f32_bf16 v33, v68, v16, 0
  v_dot2_f32_bf16 v34, v72, v16, 0
  v_dot2_f32_bf16 v35, v76, v16, 0
  v_dot2c_f32_bf16 v32, v65, v17
  v_dot2c_f32_bf16 v33, v69, v17
  v_dot2c_f32_bf16 v34, v73, v17
  v_dot2c_f32_bf16 v35, v77, v17
  v_dot2c_f32_bf16 v32, v66, v18
  v_dot2c_f32_bf16 v33, v70, v18
  v_dot2c_f32_bf16 v34, v74, v18
  v_dot2c_f32_bf16 v35, v78, v18
  v_dot2c_f32_bf16 v32, v67, v19
  v_dot2c_f32_bf16 v33, v71, v19
  v_dot2c_f32_bf16 v34, v75, v19
  v_dot2c_f32_bf16 v35, v79, v19
  v_add_f32_dpp v20, v32, v32 row_ror:8 row_mask:0xf bank_mask:0x3
  v_add_f32_dpp v21, v33, v33 row_ror:8 row_mask:0xf bank_mask:0x3
  s_nop 0
  v_add_f32_dpp v20, v34, v34 row_ror:8 row_mask:0xf bank_mask:0xc
  v_add_f32_dpp v21, v35, v35 row_ror:8 row_mask:0xf bank_mask:0xc
  s_nop 0
  v_add_f32_dpp v22, v20, v20 row_half_mirror row_mask:0xf bank_mask:0x5
  s_nop 1
  v_add_f32_dpp v22, v21, v21 row_half_mirror row_mask:0xf bank_mask:0xa
  s_waitcnt vmcnt(4)
  buffer_load_dwordx4 v[252:255], v3, s[8:11], s16 offen offset:3072 nt
  v_add_f32_dpp v22, v22, v22 quad_perm:[1,0,3,2] row_mask:0xf bank_mask:0xf
  s_nop 1
  v_add_f32_dpp v22, v22, v22 quad_perm:[2,3,0,1] row_mask:0xf bank_mask:0xf
  v_cvt_pk_bf16_f32 v22, 0, v22
  v_mul_f32 v22, s71, v22
  v_cvt_pk_bf16_f32 v22, 0, v22
  ds_write_b32 v9, v22 offset:32768
  v_max_f32 v8, v8, v22
  v_add_u32 v9, 64, v9
  v_dot2_f32_bf16 v32, v80, v16, 0
  v_dot2_f32_bf16 v33, v84, v16, 0
  v_dot2_f32_bf16 v34, v88, v16, 0
  v_dot2_f32_bf16 v35, v92, v16, 0
  v_dot2c_f32_bf16 v32, v81, v17
  v_dot2c_f32_bf16 v33, v85, v17
  v_dot2c_f32_bf16 v34, v89, v17
  v_dot2c_f32_bf16 v35, v93, v17
  v_dot2c_f32_bf16 v32, v82, v18
  v_dot2c_f32_bf16 v33, v86, v18
  v_dot2c_f32_bf16 v34, v90, v18
  v_dot2c_f32_bf16 v35, v94, v18
  v_dot2c_f32_bf16 v32, v83, v19
  v_dot2c_f32_bf16 v33, v87, v19
  v_dot2c_f32_bf16 v34, v91, v19
  v_dot2c_f32_bf16 v35, v95, v19
  s_waitcnt vmcnt(4)
  s_add_u32 s16, s16, 32768
  s_and_b32 s16, s16, 2097151
  buffer_load_dwordx4 v[64:67], v3, s[8:11], s16 offen offset:0 nt
  v_add_f32_dpp v20, v32, v32 row_ror:8 row_mask:0xf bank_mask:0x3
  v_add_f32_dpp v21, v33, v33 row_ror:8 row_mask:0xf bank_mask:0x3
  s_nop 0
  v_add_f32_dpp v20, v34, v34 row_ror:8 row_mask:0xf bank_mask:0xc
  v_add_f32_dpp v21, v35, v35 row_ror:8 row_mask:0xf bank_mask:0xc
  s_nop 0
  v_add_f32_dpp v22, v20, v20 row_half_mirror row_mask:0xf bank_mask:0x5
  s_nop 1
  v_add_f32_dpp v22, v21, v21 row_half_mirror row_mask:0xf bank_mask:0xa
  s_nop 1
  v_add_f32_dpp v22, v22, v22 quad_perm:[1,0,3,2] row_mask:0xf bank_mask:0xf
  s_nop 1
  v_add_f32_dpp v22, v22, v22 quad_perm:[2,3,0,1] row_mask:0xf bank_mask:0xf
  v_cvt_pk_bf16_f32 v22, 0, v22
  v_mul_f32 v22, s71, v22
  v_cvt_pk_bf16_f32 v22, 0, v22
  ds_write_b32 v9, v22 offset:32768
  v_max_f32 v8, v8, v22
  v_add_u32 v9, 64, v9
  v_dot2_f32_bf16 v32, v96, v16, 0
  v_dot2_f32_bf16 v33, v100, v16, 0
  v_dot2_f32_bf16 v34, v104, v16, 0
  v_dot2_f32_bf16 v35, v108, v16, 0
  v_dot2c_f32_bf16 v32, v97, v17
  v_dot2c_f32_bf16 v33, v101, v17
  v_dot2c_f32_bf16 v34, v105, v17
  v_dot2c_f32_bf16 v35, v109, v17
  s_waitcnt vmcnt(4)
  buffer_load_dwordx4 v[68:71], v3, s[8:11], s16 offen offset:1024 nt
  v_dot2c_f32_bf16 v32, v98, v18
  v_dot2c_f32_bf16 v33, v102, v18
  v_dot2c_f32_bf16 v34, v106, v18
  v_dot2c_f32_bf16 v35, v110, v18
  v_dot2c_f32_bf16 v32, v99, v19
  v_dot2c_f32_bf16 v33, v103, v19
  v_dot2c_f32_bf16 v34, v107, v19
  v_dot2c_f32_bf16 v35, v111, v19
  v_add_f32_dpp v20, v32, v32 row_ror:8 row_mask:0xf bank_mask:0x3
  v_add_f32_dpp v21, v33, v33 row_ror:8 row_mask:0xf bank_mask:0x3
  s_nop 0
  v_add_f32_dpp v20, v34, v34 row_ror:8 row_mask:0xf bank_mask:0xc
  v_add_f32_dpp v21, v35, v35 row_ror:8 row_mask:0xf bank_mask:0xc
  s_nop 0
  v_add_f32_dpp v22, v20, v20 row_half_mirror row_mask:0xf bank_mask:0x5
  s_nop 1
  v_add_f32_dpp v22, v21, v21 row_half_mirror row_mask:0xf bank_mask:0xa
  s_nop 1
  v_add_f32_dpp v22, v22, v22 quad_perm:[1,0,3,2] row_mask:0xf bank_mask:0xf
  s_nop 1
  v_add_f32_dpp v22, v22, v22 quad_perm:[2,3,0,1] row_mask:0xf bank_mask:0xf
  v_cvt_pk_bf16_f32 v22, 0, v22
  v_mul_f32 v22, s71, v22
  v_cvt_pk_bf16_f32 v22, 0, v22
  ds_write_b32 v9, v22 offset:32768
  v_max_f32 v8, v8, v22
  v_add_u32 v9, 64, v9
  s_waitcnt vmcnt(4)
  buffer_load_dwordx4 v[72:75], v3, s[8:11], s16 offen offset:2048 nt
  v_dot2_f32_bf16 v32, v112, v16, 0
  v_dot2_f32_bf16 v33, v116, v16, 0
  v_dot2_f32_bf16 v34, v120, v16, 0
  v_dot2_f32_bf16 v35, v124, v16, 0
  v_dot2c_f32_bf16 v32, v113, v17
  v_dot2c_f32_bf16 v33, v117, v17
  v_dot2c_f32_bf16 v34, v121, v17
  v_dot2c_f32_bf16 v35, v125, v17
  v_dot2c_f32_bf16 v32, v114, v18
  v_dot2c_f32_bf16 v33, v118, v18
  v_dot2c_f32_bf16 v34, v122, v18
  v_dot2c_f32_bf16 v35, v126, v18
  v_dot2c_f32_bf16 v32, v115, v19
  v_dot2c_f32_bf16 v33, v119, v19
  v_dot2c_f32_bf16 v34, v123, v19
  v_dot2c_f32_bf16 v35, v127, v19
  v_add_f32_dpp v20, v32, v32 row_ror:8 row_mask:0xf bank_mask:0x3
  v_add_f32_dpp v21, v33, v33 row_ror:8 row_mask:0xf bank_mask:0x3
  s_nop 0
  v_add_f32_dpp v20, v34, v34 row_ror:8 row_mask:0xf bank_mask:0xc
  v_add_f32_dpp v21, v35, v35 row_ror:8 row_mask:0xf bank_mask:0xc
  s_nop 0
  v_add_f32_dpp v22, v20, v20 row_half_mirror row_mask:0xf bank_mask:0x5
  s_nop 1
  v_add_f32_dpp v22, v21, v21 row_half_mirror row_mask:0xf bank_mask:0xa
  s_waitcnt vmcnt(4)
  buffer_load_dwordx4 v[76:79], v3, s[8:11], s16 offen offset:3072 nt
  v_add_f32_dpp v22, v22, v22 quad_perm:[1,0,3,2] row_mask:0xf bank_mask:0xf
  s_nop 1
  v_add_f32_dpp v22, v22, v22 quad_perm:[2,3,0,1] row_mask:0xf bank_mask:0xf
  v_cvt_pk_bf16_f32 v22, 0, v22
  v_mul_f32 v22, s71, v22
  v_cvt_pk_bf16_f32 v22, 0, v22
  ds_write_b32 v9, v22 offset:32768
  v_max_f32 v8, v8, v22
  v_add_u32 v9, 64, v9
  v_dot2_f32_bf16 v32, v128, v16, 0
  v_dot2_f32_bf16 v33, v132, v16, 0
  v_dot2_f32_bf16 v34, v136, v16, 0
  v_dot2_f32_bf16 v35, v140, v16, 0
  v_dot2c_f32_bf16 v32, v129, v17
  v_dot2c_f32_bf16 v33, v133, v17
  v_dot2c_f32_bf16 v34, v137, v17
  v_dot2c_f32_bf16 v35, v141, v17
  v_dot2c_f32_bf16 v32, v130, v18
  v_dot2c_f32_bf16 v33, v134, v18
  v_dot2c_f32_bf16 v34, v138, v18
  v_dot2c_f32_bf16 v35, v142, v18
  v_dot2c_f32_bf16 v32, v131, v19
  v_dot2c_f32_bf16 v33, v135, v19
  v_dot2c_f32_bf16 v34, v139, v19
  v_dot2c_f32_bf16 v35, v143, v19
  s_waitcnt vmcnt(4)
  s_add_u32 s16, s16, 32768
  s_and_b32 s16, s16, 2097151
  buffer_load_dwordx4 v[80:83], v3, s[8:11], s16 offen offset:0 nt
  v_add_f32_dpp v20, v32, v32 row_ror:8 row_mask:0xf bank_mask:0x3
  v_add_f32_dpp v21, v33, v33 row_ror:8 row_mask:0xf bank_mask:0x3
  s_nop 0
  v_add_f32_dpp v20, v34, v34 row_ror:8 row_mask:0xf bank_mask:0xc
  v_add_f32_dpp v21, v35, v35 row_ror:8 row_mask:0xf bank_mask:0xc
  s_nop 0
  v_add_f32_dpp v22, v20, v20 row_half_mirror row_mask:0xf bank_mask:0x5
  s_nop 1
  v_add_f32_dpp v22, v21, v21 row_half_mirror row_mask:0xf bank_mask:0xa
  s_nop 1
  v_add_f32_dpp v22, v22, v22 quad_perm:[1,0,3,2] row_mask:0xf bank_mask:0xf
  s_nop 1
  v_add_f32_dpp v22, v22, v22 quad_perm:[2,3,0,1] row_mask:0xf bank_mask:0xf
  v_cvt_pk_bf16_f32 v22, 0, v22
  v_mul_f32 v22, s71, v22
  v_cvt_pk_bf16_f32 v22, 0, v22
  ds_write_b32 v9, v22 offset:32768
  v_max_f32 v8, v8, v22
  v_add_u32 v9, 64, v9
  v_dot2_f32_bf16 v32, v144, v16, 0
  v_dot2_f32_bf16 v33, v148, v16, 0
  v_dot2_f32_bf16 v34, v152, v16, 0
  v_dot2_f32_bf16 v35, v156, v16, 0
  v_dot2c_f32_bf16 v32, v145, v17
  v_dot2c_f32_bf16 v33, v149, v17
  v_dot2c_f32_bf16 v34, v153, v17
  v_dot2c_f32_bf16 v35, v157, v17
  s_waitcnt vmcnt(4)
  buffer_load_dwordx4 v[84:87], v3, s[8:11], s16 offen offset:1024 nt
  v_dot2c_f32_bf16 v32, v146, v18
  v_dot2c_f32_bf16 v33, v150, v18
  v_dot2c_f32_bf16 v34, v154, v18
  v_dot2c_f32_bf16 v35, v158, v18
  v_dot2c_f32_bf16 v32, v147, v19
  v_dot2c_f32_bf16 v33, v151, v19
  v_dot2c_f32_bf16 v34, v155, v19
  v_dot2c_f32_bf16 v35, v159, v19
  v_add_f32_dpp v20, v32, v32 row_ror:8 row_mask:0xf bank_mask:0x3
  v_add_f32_dpp v21, v33, v33 row_ror:8 row_mask:0xf bank_mask:0x3
  s_nop 0
  v_add_f32_dpp v20, v34, v34 row_ror:8 row_mask:0xf bank_mask:0xc
  v_add_f32_dpp v21, v35, v35 row_ror:8 row_mask:0xf bank_mask:0xc
  s_nop 0
  v_add_f32_dpp v22, v20, v20 row_half_mirror row_mask:0xf bank_mask:0x5
  s_nop 1
  v_add_f32_dpp v22, v21, v21 row_half_mirror row_mask:0xf bank_mask:0xa
  s_nop 1
  v_add_f32_dpp v22, v22, v22 quad_perm:[1,0,3,2] row_mask:0xf bank_mask:0xf
  s_nop 1
  v_add_f32_dpp v22, v22, v22 quad_perm:[2,3,0,1] row_mask:0xf bank_mask:0xf
  v_cvt_pk_bf16_f32 v22, 0, v22
  v_mul_f32 v22, s71, v22
  v_cvt_pk_bf16_f32 v22, 0, v22
  ds_write_b32 v9, v22 offset:32768
  v_max_f32 v8, v8, v22
  v_add_u32 v9, 64, v9
  s_waitcnt vmcnt(4)
  buffer_load_dwordx4 v[88:91], v3, s[8:11], s16 offen offset:2048 nt
  v_dot2_f32_bf16 v32, v160, v16, 0
  v_dot2_f32_bf16 v33, v164, v16, 0
  v_dot2_f32_bf16 v34, v168, v16, 0
  v_dot2_f32_bf16 v35, v172, v16, 0
  v_dot2c_f32_bf16 v32, v161, v17
  v_dot2c_f32_bf16 v33, v165, v17
  v_dot2c_f32_bf16 v34, v169, v17
  v_dot2c_f32_bf16 v35, v173, v17
  v_dot2c_f32_bf16 v32, v162, v18
  v_dot2c_f32_bf16 v33, v166, v18
  v_dot2c_f32_bf16 v34, v170, v18
  v_dot2c_f32_bf16 v35, v174, v18
  v_dot2c_f32_bf16 v32, v163, v19
  v_dot2c_f32_bf16 v33, v167, v19
  v_dot2c_f32_bf16 v34, v171, v19
  v_dot2c_f32_bf16 v35, v175, v19
  v_add_f32_dpp v20, v32, v32 row_ror:8 row_mask:0xf bank_mask:0x3
  v_add_f32_dpp v21, v33, v33 row_ror:8 row_mask:0xf bank_mask:0x3
  s_nop 0
  v_add_f32_dpp v20, v34, v34 row_ror:8 row_mask:0xf bank_mask:0xc
  v_add_f32_dpp v21, v35, v35 row_ror:8 row_mask:0xf bank_mask:0xc
  s_nop 0
  v_add_f32_dpp v22, v20, v20 row_half_mirror row_mask:0xf bank_mask:0x5
  s_nop 1
  v_add_f32_dpp v22, v21, v21 row_half_mirror row_mask:0xf bank_mask:0xa
  s_waitcnt vmcnt(4)
  buffer_load_dwordx4 v[92:95], v3, s[8:11], s16 offen offset:3072 nt
  v_add_f32_dpp v22, v22, v22 quad_perm:[1,0,3,2] row_mask:0xf bank_mask:0xf
  s_nop 1
  v_add_f32_dpp v22, v22, v22 quad_perm:[2,3,0,1] row_mask:0xf bank_mask:0xf
  v_cvt_pk_bf16_f32 v22, 0, v22
  v_mul_f32 v22, s71, v22
  v_cvt_pk_bf16_f32 v22, 0, v22
  ds_write_b32 v9, v22 offset:32768
  v_max_f32 v8, v8, v22
  v_add_u32 v9, 64, v9
  v_dot2_f32_bf16 v32, v176, v16, 0
  v_dot2_f32_bf16 v33, v180, v16, 0
  v_dot2_f32_bf16 v34, v184, v16, 0
  v_dot2_f32_bf16 v35, v188, v16, 0
  v_dot2c_f32_bf16 v32, v177, v17
  v_dot2c_f32_bf16 v33, v181, v17
  v_dot2c_f32_bf16 v34, v185, v17
  v_dot2c_f32_bf16 v35, v189, v17
  v_dot2c_f32_bf16 v32, v178, v18
  v_dot2c_f32_bf16 v33, v182, v18
  v_dot2c_f32_bf16 v34, v186, v18
  v_dot2c_f32_bf16 v35, v190, v18
  v_dot2c_f32_bf16 v32, v179, v19
  v_dot2c_f32_bf16 v33, v183, v19
  v_dot2c_f32_bf16 v34, v187, v19
  v_dot2c_f32_bf16 v35, v191, v19
  s_waitcnt vmcnt(4)
  s_add_u32 s16, s16, 32768
  s_and_b32 s16, s16, 2097151
  buffer_load_dwordx4 v[96:99], v3, s[8:11], s16 offen offset:0 nt
  v_add_f32_dpp v20, v32, v32 row_ror:8 row_mask:0xf bank_mask:0x3
  v_add_f32_dpp v21, v33, v33 row_ror:8 row_mask:0xf bank_mask:0x3
  s_nop 0
  v_add_f32_dpp v20, v34, v34 row_ror:8 row_mask:0xf bank_mask:0xc
  v_add_f32_dpp v21, v35, v35 row_ror:8 row_mask:0xf bank_mask:0xc
  s_nop 0
  v_add_f32_dpp v22, v20, v20 row_half_mirror row_mask:0xf bank_mask:0x5
  s_nop 1
  v_add_f32_dpp v22, v21, v21 row_half_mirror row_mask:0xf bank_mask:0xa
  s_nop 1
  v_add_f32_dpp v22, v22, v22 quad_perm:[1,0,3,2] row_mask:0xf bank_mask:0xf
  s_nop 1
  v_add_f32_dpp v22, v22, v22 quad_perm:[2,3,0,1] row_mask:0xf bank_mask:0xf
  v_cvt_pk_bf16_f32 v22, 0, v22
  v_mul_f32 v22, s71, v22
  v_cvt_pk_bf16_f32 v22, 0, v22
  ds_write_b32 v9, v22 offset:32768
  v_max_f32 v8, v8, v22
  v_add_u32 v9, 64, v9
  v_dot2_f32_bf16 v32, v192, v16, 0
  v_dot2_f32_bf16 v33, v196, v16, 0
  v_dot2_f32_bf16 v34, v200, v16, 0
  v_dot2_f32_bf16 v35, v204, v16, 0
  v_dot2c_f32_bf16 v32, v193, v17
  v_dot2c_f32_bf16 v33, v197, v17
  v_dot2c_f32_bf16 v34, v201, v17
  v_dot2c_f32_bf16 v35, v205, v17
  s_waitcnt vmcnt(4)
  buffer_load_dwordx4 v[100:103], v3, s[8:11], s16 offen offset:1024 nt
  v_dot2c_f32_bf16 v32, v194, v18
  v_dot2c_f32_bf16 v33, v198, v18
  v_dot2c_f32_bf16 v34, v202, v18
  v_dot2c_f32_bf16 v35, v206, v18
  v_dot2c_f32_bf16 v32, v195, v19
  v_dot2c_f32_bf16 v33, v199, v19
  v_dot2c_f32_bf16 v34, v203, v19
  v_dot2c_f32_bf16 v35, v207, v19
  v_add_f32_dpp v20, v32, v32 row_ror:8 row_mask:0xf bank_mask:0x3
  v_add_f32_dpp v21, v33, v33 row_ror:8 row_mask:0xf bank_mask:0x3
  s_nop 0
  v_add_f32_dpp v20, v34, v34 row_ror:8 row_mask:0xf bank_mask:0xc
  v_add_f32_dpp v21, v35, v35 row_ror:8 row_mask:0xf bank_mask:0xc
  s_nop 0
  v_add_f32_dpp v22, v20, v20 row_half_mirror row_mask:0xf bank_mask:0x5
  s_nop 1
  v_add_f32_dpp v22, v21, v21 row_half_mirror row_mask:0xf bank_mask:0xa
  s_nop 1
  v_add_f32_dpp v22, v22, v22 quad_perm:[1,0,3,2] row_mask:0xf bank_mask:0xf
  s_nop 1
  v_add_f32_dpp v22, v22, v22 quad_perm:[2,3,0,1] row_mask:0xf bank_mask:0xf
  v_cvt_pk_bf16_f32 v22, 0, v22
  v_mul_f32 v22, s71, v22
  v_cvt_pk_bf16_f32 v22, 0, v22
  ds_write_b32 v9, v22 offset:32768
  v_max_f32 v8, v8, v22
  v_add_u32 v9, 64, v9
  s_waitcnt vmcnt(4)
  buffer_load_dwordx4 v[104:107], v3, s[8:11], s16 offen offset:2048 nt
  v_dot2_f32_bf16 v32, v208, v16, 0
  v_dot2_f32_bf16 v33, v212, v16, 0
  v_dot2_f32_bf16 v34, v216, v16, 0
  v_dot2_f32_bf16 v35, v220, v16, 0
  v_dot2c_f32_bf16 v32, v209, v17
  v_dot2c_f32_bf16 v33, v213, v17
  v_dot2c_f32_bf16 v34, v217, v17
  v_dot2c_f32_bf16 v35, v221, v17
  v_dot2c_f32_bf16 v32, v210, v18
  v_dot2c_f32_bf16 v33, v214, v18
  v_dot2c_f32_bf16 v34, v218, v18
  v_dot2c_f32_bf16 v35, v222, v18
  v_dot2c_f32_bf16 v32, v211, v19
  v_dot2c_f32_bf16 v33, v215, v19
  v_dot2c_f32_bf16 v34, v219, v19
  v_dot2c_f32_bf16 v35, v223, v19
  v_add_f32_dpp v20, v32, v32 row_ror:8 row_mask:0xf bank_mask:0x3
  v_add_f32_dpp v21, v33, v33 row_ror:8 row_mask:0xf bank_mask:0x3
  s_nop 0
  v_add_f32_dpp v20, v34, v34 row_ror:8 row_mask:0xf bank_mask:0xc
  v_add_f32_dpp v21, v35, v35 row_ror:8 row_mask:0xf bank_mask:0xc
  s_nop 0
  v_add_f32_dpp v22, v20, v20 row_half_mirror row_mask:0xf bank_mask:0x5
  s_nop 1
  v_add_f32_dpp v22, v21, v21 row_half_mirror row_mask:0xf bank_mask:0xa
  s_waitcnt vmcnt(4)
  buffer_load_dwordx4 v[108:111], v3, s[8:11], s16 offen offset:3072 nt
  v_add_f32_dpp v22, v22, v22 quad_perm:[1,0,3,2] row_mask:0xf bank_mask:0xf
  s_nop 1
  v_add_f32_dpp v22, v22, v22 quad_perm:[2,3,0,1] row_mask:0xf bank_mask:0xf
  v_cvt_pk_bf16_f32 v22, 0, v22
  v_mul_f32 v22, s71, v22
  v_cvt_pk_bf16_f32 v22, 0, v22
  ds_write_b32 v9, v22 offset:32768
  v_max_f32 v8, v8, v22
  v_add_u32 v9, 64, v9
  v_dot2_f32_bf16 v32, v224, v16, 0
  v_dot2_f32_bf16 v33, v228, v16, 0
  v_dot2_f32_bf16 v34, v232, v16, 0
  v_dot2_f32_bf16 v35, v236, v16, 0
  v_dot2c_f32_bf16 v32, v225, v17
  v_dot2c_f32_bf16 v33, v229, v17
  v_dot2c_f32_bf16 v34, v233, v17
  v_dot2c_f32_bf16 v35, v237, v17
  v_dot2c_f32_bf16 v32, v226, v18
  v_dot2c_f32_bf16 v33, v230, v18
  v_dot2c_f32_bf16 v34, v234, v18
  v_dot2c_f32_bf16 v35, v238, v18
  v_dot2c_f32_bf16 v32, v227, v19
  v_dot2c_f32_bf16 v33, v231, v19
  v_dot2c_f32_bf16 v34, v235, v19
  v_dot2c_f32_bf16 v35, v239, v19
  s_waitcnt vmcnt(4)
  s_add_u32 s16, s16, 32768
  s_and_b32 s16, s16, 2097151
  buffer_load_dwordx4 v[112:115], v3, s[8:11], s16 offen offset:0 nt
  v_add_f32_dpp v20, v32, v32 row_ror:8 row_mask:0xf bank_mask:0x3
  v_add_f32_dpp v21, v33, v33 row_ror:8 row_mask:0xf bank_mask:0x3
  s_nop 0
  v_add_f32_dpp v20, v34, v34 row_ror:8 row_mask:0xf bank_mask:0xc
  v_add_f32_dpp v21, v35, v35 row_ror:8 row_mask:0xf bank_mask:0xc
  s_nop 0
  v_add_f32_dpp v22, v20, v20 row_half_mirror row_mask:0xf bank_mask:0x5
  s_nop 1
  v_add_f32_dpp v22, v21, v21 row_half_mirror row_mask:0xf bank_mask:0xa
  s_nop 1
  v_add_f32_dpp v22, v22, v22 quad_perm:[1,0,3,2] row_mask:0xf bank_mask:0xf
  s_nop 1
  v_add_f32_dpp v22, v22, v22 quad_perm:[2,3,0,1] row_mask:0xf bank_mask:0xf
  v_cvt_pk_bf16_f32 v22, 0, v22
  v_mul_f32 v22, s71, v22
  v_cvt_pk_bf16_f32 v22, 0, v22
  ds_write_b32 v9, v22 offset:32768
  v_max_f32 v8, v8, v22
  v_add_u32 v9, 64, v9
  v_dot2_f32_bf16 v32, v240, v16, 0
  v_dot2_f32_bf16 v33, v244, v16, 0
  v_dot2_f32_bf16 v34, v248, v16, 0
  v_dot2_f32_bf16 v35, v252, v16, 0
  v_dot2c_f32_bf16 v32, v241, v17
  v_dot2c_f32_bf16 v33, v245, v17
  v_dot2c_f32_bf16 v34, v249, v17
  v_dot2c_f32_bf16 v35, v253, v17
  s_waitcnt vmcnt(4)
  buffer_load_dwordx4 v[116:119], v3, s[8:11], s16 offen offset:1024 nt
  v_dot2c_f32_bf16 v32, v242, v18
  v_dot2c_f32_bf16 v33, v246, v18
  v_dot2c_f32_bf16 v34, v250, v18
  v_dot2c_f32_bf16 v35, v254, v18
  v_dot2c_f32_bf16 v32, v243, v19
  v_dot2c_f32_bf16 v33, v247, v19
  v_dot2c_f32_bf16 v34, v251, v19
  v_dot2c_f32_bf16 v35, v255, v19
  v_add_f32_dpp v20, v32, v32 row_ror:8 row_mask:0xf bank_mask:0x3
  v_add_f32_dpp v21, v33, v33 row_ror:8 row_mask:0xf bank_mask:0x3
  s_nop 0
  v_add_f32_dpp v20, v34, v34 row_ror:8 row_mask:0xf bank_mask:0xc
  v_add_f32_dpp v21, v35, v35 row_ror:8 row_mask:0xf bank_mask:0xc
  s_nop 0
  v_add_f32_dpp v22, v20, v20 row_half_mirror row_mask:0xf bank_mask:0x5
  s_nop 1
  v_add_f32_dpp v22, v21, v21 row_half_mirror row_mask:0xf bank_mask:0xa
  s_nop 1
  v_add_f32_dpp v22, v22, v22 quad_perm:[1,0,3,2] row_mask:0xf bank_mask:0xf
  s_nop 1
  v_add_f32_dpp v22, v22, v22 quad_perm:[2,3,0,1] row_mask:0xf bank_mask:0xf
  v_cvt_pk_bf16_f32 v22, 0, v22
  v_mul_f32 v22, s71, v22
  v_cvt_pk_bf16_f32 v22, 0, v22
  ds_write_b32 v9, v22 offset:32768
  v_max_f32 v8, v8, v22
  v_add_u32 v9, 64, v9
  s_waitcnt vmcnt(4)
  buffer_load_dwordx4 v[120:123], v3, s[8:11], s16 offen offset:2048 nt
  v_dot2_f32_bf16 v32, v64, v16, 0
  v_dot2_f32_bf16 v33, v68, v16, 0
  v_dot2_f32_bf16 v34, v72, v16, 0
  v_dot2_f32_bf16 v35, v76, v16, 0
  v_dot2c_f32_bf16 v32, v65, v17
  v_dot2c_f32_bf16 v33, v69, v17
  v_dot2c_f32_bf16 v34, v73, v17
  v_dot2c_f32_bf16 v35, v77, v17
  v_dot2c_f32_bf16 v32, v66, v18
  v_dot2c_f32_bf16 v33, v70, v18
  v_dot2c_f32_bf16 v34, v74, v18
  v_dot2c_f32_bf16 v35, v78, v18
  v_dot2c_f32_bf16 v32, v67, v19
  v_dot2c_f32_bf16 v33, v71, v19
  v_dot2c_f32_bf16 v34, v75, v19
  v_dot2c_f32_bf16 v35, v79, v19
  v_add_f32_dpp v20, v32, v32 row_ror:8 row_mask:0xf bank_mask:0x3
  v_add_f32_dpp v21, v33, v33 row_ror:8 row_mask:0xf bank_mask:0x3
  s_nop 0
  v_add_f32_dpp v20, v34, v34 row_ror:8 row_mask:0xf bank_mask:0xc
  v_add_f32_dpp v21, v35, v35 row_ror:8 row_mask:0xf bank_mask:0xc
  s_nop 0
  v_add_f32_dpp v22, v20, v20 row_half_mirror row_mask:0xf bank_mask:0x5
  s_nop 1
  v_add_f32_dpp v22, v21, v21 row_half_mirror row_mask:0xf bank_mask:0xa
  s_waitcnt vmcnt(4)
  buffer_load_dwordx4 v[124:127], v3, s[8:11], s16 offen offset:3072 nt
  v_add_f32_dpp v22, v22, v22 quad_perm:[1,0,3,2] row_mask:0xf bank_mask:0xf
  s_nop 1
  v_add_f32_dpp v22, v22, v22 quad_perm:[2,3,0,1] row_mask:0xf bank_mask:0xf
  v_cvt_pk_bf16_f32 v22, 0, v22
  v_mul_f32 v22, s71, v22
  v_cvt_pk_bf16_f32 v22, 0, v22
  ds_write_b32 v9, v22 offset:32768
  v_max_f32 v8, v8, v22
  v_add_u32 v9, 64, v9
  v_dot2_f32_bf16 v32, v80, v16, 0
  v_dot2_f32_bf16 v33, v84, v16, 0
  v_dot2_f32_bf16 v34, v88, v16, 0
  v_dot2_f32_bf16 v35, v92, v16, 0
  v_dot2c_f32_bf16 v32, v81, v17
  v_dot2c_f32_bf16 v33, v85, v17
  v_dot2c_f32_bf16 v34, v89, v17
  v_dot2c_f32_bf16 v35, v93, v17
  s_waitcnt vmcnt(4)
  s_add_u32 s16, s16, 32768
  s_and_b32 s16, s16, 2097151
  buffer_load_dwordx4 v[64:67], v3, s[8:11], s16 offen offset:0 nt
  v_dot2c_f32_bf16 v32, v82, v18
  v_dot2c_f32_bf16 v33, v86, v18
  v_dot2c_f32_bf16 v34, v90, v18
  v_dot2c_f32_bf16 v35, v94, v18
  v_dot2c_f32_bf16 v32, v83, v19
  v_dot2c_f32_bf16 v33, v87, v19
  v_dot2c_f32_bf16 v34, v91, v19
  v_dot2c_f32_bf16 v35, v95, v19
  s_waitcnt vmcnt(4)
  buffer_load_dwordx4 v[68:71], v3, s[8:11], s16 offen offset:1024 nt
  v_add_f32_dpp v20, v32, v32 row_ror:8 row_mask:0xf bank_mask:0x3
  v_add_f32_dpp v21, v33, v33 row_ror:8 row_mask:0xf bank_mask:0x3
  s_nop 0
  v_add_f32_dpp v20, v34, v34 row_ror:8 row_mask:0xf bank_mask:0xc
  v_add_f32_dpp v21, v35, v35 row_ror:8 row_mask:0xf bank_mask:0xc
  s_nop 0
  v_add_f32_dpp v22, v20, v20 row_half_mirror row_mask:0xf bank_mask:0x5
  s_nop 1
  v_add_f32_dpp v22, v21, v21 row_half_mirror row_mask:0xf bank_mask:0xa
  s_waitcnt vmcnt(4)
  buffer_load_dwordx4 v[72:75], v3, s[8:11], s16 offen offset:2048 nt
  v_add_f32_dpp v22, v22, v22 quad_perm:[1,0,3,2] row_mask:0xf bank_mask:0xf
  s_nop 1
  v_add_f32_dpp v22, v22, v22 quad_perm:[2,3,0,1] row_mask:0xf bank_mask:0xf
  v_cvt_pk_bf16_f32 v22, 0, v22
  v_mul_f32 v22, s71, v22
  v_cvt_pk_bf16_f32 v22, 0, v22
  ds_write_b32 v9, v22 offset:32768
  v_max_f32 v8, v8, v22
  v_add_u32 v9, 64, v9
  s_waitcnt vmcnt(4)
  buffer_load_dwordx4 v[76:79], v3, s[8:11], s16 offen offset:3072 nt
  v_dot2_f32_bf16 v32, v96, v16, 0
  v_dot2_f32_bf16 v33, v100, v16, 0
  v_dot2_f32_bf16 v34, v104, v16, 0
  v_dot2_f32_bf16 v35, v108, v16, 0
  v_dot2c_f32_bf16 v32, v97, v17
  v_dot2c_f32_bf16 v33, v101, v17
  v_dot2c_f32_bf16 v34, v105, v17
  v_dot2c_f32_bf16 v35, v109, v17
  s_waitcnt vmcnt(4)
  s_add_u32 s16, s16, 32768
  s_and_b32 s16, s16, 2097151
  buffer_load_dwordx4 v[80:83], v3, s[8:11], s16 offen offset:0 nt
  v_dot2c_f32_bf16 v32, v98, v18
  v_dot2c_f32_bf16 v33, v102, v18
  v_dot2c_f32_bf16 v34, v106, v18
  v_dot2c_f32_bf16 v35, v110, v18
  v_dot2c_f32_bf16 v32, v99, v19
  v_dot2c_f32_bf16 v33, v103, v19
  v_dot2c_f32_bf16 v34, v107, v19
  v_dot2c_f32_bf16 v35, v111, v19
  s_waitcnt vmcnt(4)
  buffer_load_dwordx4 v[84:87], v3, s[8:11], s16 offen offset:1024 nt
  v_add_f32_dpp v20, v32, v32 row_ror:8 row_mask:0xf bank_mask:0x3
  v_add_f32_dpp v21, v33, v33 row_ror:8 row_mask:0xf bank_mask:0x3
  s_nop 0
  v_add_f32_dpp v20, v34, v34 row_ror:8 row_mask:0xf bank_mask:0xc
  v_add_f32_dpp v21, v35, v35 row_ror:8 row_mask:0xf bank_mask:0xc
  s_nop 0
  v_add_f32_dpp v22, v20, v20 row_half_mirror row_mask:0xf bank_mask:0x5
  s_nop 1
  v_add_f32_dpp v22, v21, v21 row_half_mirror row_mask:0xf bank_mask:0xa
  s_waitcnt vmcnt(4)
  buffer_load_dwordx4 v[88:91], v3, s[8:11], s16 offen offset:2048 nt
  v_add_f32_dpp v22, v22, v22 quad_perm:[1,0,3,2] row_mask:0xf bank_mask:0xf
  s_nop 1
  v_add_f32_dpp v22, v22, v22 quad_perm:[2,3,0,1] row_mask:0xf bank_mask:0xf
  v_cvt_pk_bf16_f32 v22, 0, v22
  v_mul_f32 v22, s71, v22
  v_cvt_pk_bf16_f32 v22, 0, v22
  ds_write_b32 v9, v22 offset:32768
  v_max_f32 v8, v8, v22
  v_add_u32 v9, 64, v9
  s_waitcnt vmcnt(4)
  buffer_load_dwordx4 v[92:95], v3, s[8:11], s16 offen offset:3072 nt
  v_dot2_f32_bf16 v32, v112, v16, 0
  v_dot2_f32_bf16 v33, v116, v16, 0
  v_dot2_f32_bf16 v34, v120, v16, 0
  v_dot2_f32_bf16 v35, v124, v16, 0
  v_dot2c_f32_bf16 v32, v113, v17
  v_dot2c_f32_bf16 v33, v117, v17
  v_dot2c_f32_bf16 v34, v121, v17
  v_dot2c_f32_bf16 v35, v125, v17
  s_waitcnt vmcnt(4)
  s_add_u32 s16, s16, 32768
  s_and_b32 s16, s16, 2097151
  buffer_load_dwordx4 v[96:99], v3, s[8:11], s16 offen offset:0 nt
  v_dot2c_f32_bf16 v32, v114, v18
  v_dot2c_f32_bf16 v33, v118, v18
  v_dot2c_f32_bf16 v34, v122, v18
  v_dot2c_f32_bf16 v35, v126, v18
  v_dot2c_f32_bf16 v32, v115, v19
  v_dot2c_f32_bf16 v33, v119, v19
  v_dot2c_f32_bf16 v34, v123, v19
  v_dot2c_f32_bf16 v35, v127, v19
  s_waitcnt vmcnt(4)
  buffer_load_dwordx4 v[100:103], v3, s[8:11], s16 offen offset:1024 nt
  v_add_f32_dpp v20, v32, v32 row_ror:8 row_mask:0xf bank_mask:0x3
  v_add_f32_dpp v21, v33, v33 row_ror:8 row_mask:0xf bank_mask:0x3
  s_nop 0
  v_add_f32_dpp v20, v34, v34 row_ror:8 row_mask:0xf bank_mask:0xc
  v_add_f32_dpp v21, v35, v35 row_ror:8 row_mask:0xf bank_mask:0xc
  s_nop 0
  v_add_f32_dpp v22, v20, v20 row_half_mirror row_mask:0xf bank_mask:0x5
  s_nop 1
  v_add_f32_dpp v22, v21, v21 row_half_mirror row_mask:0xf bank_mask:0xa
  s_waitcnt vmcnt(4)
  buffer_load_dwordx4 v[104:107], v3, s[8:11], s16 offen offset:2048 nt
  v_add_f32_dpp v22, v22, v22 quad_perm:[1,0,3,2] row_mask:0xf bank_mask:0xf
  s_nop 1
  v_add_f32_dpp v22, v22, v22 quad_perm:[2,3,0,1] row_mask:0xf bank_mask:0xf
  v_cvt_pk_bf16_f32 v22, 0, v22
  v_mul_f32 v22, s71, v22
  v_cvt_pk_bf16_f32 v22, 0, v22
  ds_write_b32 v9, v22 offset:32768
  v_max_f32 v8, v8, v22
  v_add_u32 v9, 64, v9
  s_waitcnt vmcnt(4)
  buffer_load_dwordx4 v[108:111], v3, s[8:11], s16 offen offset:3072 nt
  v_dot2_f32_bf16 v32, v64, v16, 0
  v_dot2_f32_bf16 v33, v68, v16, 0
  v_dot2_f32_bf16 v34, v72, v16, 0
  v_dot2_f32_bf16 v35, v76, v16, 0
  v_dot2c_f32_bf16 v32, v65, v17
  v_dot2c_f32_bf16 v33, v69, v17
  v_dot2c_f32_bf16 v34, v73, v17
  v_dot2c_f32_bf16 v35, v77, v17
  s_waitcnt vmcnt(4)
  s_add_u32 s16, s16, 32768
  s_and_b32 s16, s16, 2097151
  buffer_load_dwordx4 v[112:115], v3, s[8:11], s16 offen offset:0 nt
  v_dot2c_f32_bf16 v32, v66, v18
  v_dot2c_f32_bf16 v33, v70, v18
  v_dot2c_f32_bf16 v34, v74, v18
  v_dot2c_f32_bf16 v35, v78, v18
  v_dot2c_f32_bf16 v32, v67, v19
  v_dot2c_f32_bf16 v33, v71, v19
  v_dot2c_f32_bf16 v34, v75, v19
  v_dot2c_f32_bf16 v35, v79, v19
  s_waitcnt vmcnt(4)
  buffer_load_dwordx4 v[116:119], v3, s[8:11], s16 offen offset:1024 nt
  v_add_f32_dpp v20, v32, v32 row_ror:8 row_mask:0xf bank_mask:0x3
  v_add_f32_dpp v21, v33, v33 row_ror:8 row_mask:0xf bank_mask:0x3
  s_nop 0
  v_add_f32_dpp v20, v34, v34 row_ror:8 row_mask:0xf bank_mask:0xc
  v_add_f32_dpp v21, v35, v35 row_ror:8 row_mask:0xf bank_mask:0xc
  s_nop 0
  v_add_f32_dpp v22, v20, v20 row_half_mirror row_mask:0xf bank_mask:0x5
  s_nop 1
  v_add_f32_dpp v22, v21, v21 row_half_mirror row_mask:0xf bank_mask:0xa
  s_waitcnt vmcnt(4)
  buffer_load_dwordx4 v[120:123], v3, s[8:11], s16 offen offset:2048 nt
  v_add_f32_dpp v22, v22, v22 quad_perm:[1,0,3,2] row_mask:0xf bank_mask:0xf
  s_nop 1
  v_add_f32_dpp v22, v22, v22 quad_perm:[2,3,0,1] row_mask:0xf bank_mask:0xf
  v_cvt_pk_bf16_f32 v22, 0, v22
  v_mul_f32 v22, s71, v22
  v_cvt_pk_bf16_f32 v22, 0, v22
  ds_write_b32 v9, v22 offset:32768
  v_max_f32 v8, v8, v22
  v_add_u32 v9, 64, v9
  s_waitcnt vmcnt(4)
  buffer_load_dwordx4 v[124:127], v3, s[8:11], s16 offen offset:3072 nt
  v_dot2_f32_bf16 v32, v80, v16, 0
  v_dot2_f32_bf16 v33, v84, v16, 0
  v_dot2_f32_bf16 v34, v88, v16, 0
  v_dot2_f32_bf16 v35, v92, v16, 0
  v_dot2c_f32_bf16 v32, v81, v17
  v_dot2c_f32_bf16 v33, v85, v17
  v_dot2c_f32_bf16 v34, v89, v17
  v_dot2c_f32_bf16 v35, v93, v17
  v_lshlrev_b32 v11, 4, v1
  v_add_u32 v11, s74, v11
  s_waitcnt vmcnt(4)
  s_add_u32 s16, s16, 32768
  s_and_b32 s16, s16, 2097151
  buffer_load_dwordx4 v[64:67], v3, s[8:11], s16 offen offset:0 nt
  v_dot2c_f32_bf16 v32, v82, v18
  v_dot2c_f32_bf16 v33, v86, v18
  v_dot2c_f32_bf16 v34, v90, v18
  v_dot2c_f32_bf16 v35, v94, v18
  v_dot2c_f32_bf16 v32, v83, v19
  v_dot2c_f32_bf16 v33, v87, v19
  v_dot2c_f32_bf16 v34, v91, v19
  v_dot2c_f32_bf16 v35, v95, v19
  ds_read_b128 v[128:131], v11 offset:0
  ds_read_b128 v[132:135], v11 offset:1024
  ds_read_b128 v[136:139], v11 offset:2048
  ds_read_b128 v[140:143], v11 offset:3072
  s_waitcnt lgkmcnt(0)
  ds_read_b128 v[144:147], v11 offset:4096
  ds_read_b128 v[148:151], v11 offset:5120
  ds_read_b128 v[152:155], v11 offset:6144
  ds_read_b128 v[156:159], v11 offset:7168
  v_dot2_f32_bf16 v40, v128, v16, 0
  v_dot2_f32_bf16 v41, v132, v16, 0
  v_dot2_f32_bf16 v42, v136, v16, 0
  v_dot2_f32_bf16 v43, v140, v16, 0
  v_dot2c_f32_bf16 v40, v129, v17
  v_dot2c_f32_bf16 v41, v133, v17
  v_dot2c_f32_bf16 v42, v137, v17
  v_dot2c_f32_bf16 v43, v141, v17
  s_waitcnt vmcnt(4)
  buffer_load_dwordx4 v[68:71], v3, s[8:11], s16 offen offset:1024 nt
  v_add_f32_dpp v20, v32, v32 row_ror:8 row_mask:0xf bank_mask:0x3
  v_add_f32_dpp v21, v33, v33 row_ror:8 row_mask:0xf bank_mask:0x3
  s_nop 0
  v_add_f32_dpp v20, v34, v34 row_ror:8 row_mask:0xf bank_mask:0xc
  v_add_f32_dpp v21, v35, v35 row_ror:8 row_mask:0xf bank_mask:0xc
  s_nop 0
  v_add_f32_dpp v22, v20, v20 row_half_mirror row_mask:0xf bank_mask:0x5
  s_nop 1
  v_add_f32_dpp v22, v21, v21 row_half_mirror row_mask:0xf bank_mask:0xa
  v_dot2c_f32_bf16 v40, v130, v18
  v_dot2c_f32_bf16 v41, v134, v18
  v_dot2c_f32_bf16 v42, v138, v18
  v_dot2c_f32_bf16 v43, v142, v18
  v_dot2c_f32_bf16 v40, v131, v19
  v_dot2c_f32_bf16 v41, v135, v19
  v_dot2c_f32_bf16 v42, v139, v19
  v_dot2c_f32_bf16 v43, v143, v19
  s_waitcnt vmcnt(4)
  buffer_load_dwordx4 v[72:75], v3, s[8:11], s16 offen offset:2048 nt
  v_add_f32_dpp v22, v22, v22 quad_perm:[1,0,3,2] row_mask:0xf bank_mask:0xf
  s_nop 1
  v_add_f32_dpp v22, v22, v22 quad_perm:[2,3,0,1] row_mask:0xf bank_mask:0xf
  v_cvt_pk_bf16_f32 v22, 0, v22
  v_mul_f32 v22, s71, v22
  v_cvt_pk_bf16_f32 v22, 0, v22
  ds_write_b32 v9, v22 offset:32768
  v_max_f32 v8, v8, v22
  v_add_u32 v9, 64, v9
  v_add_f32_dpp v44, v40, v40 row_ror:8 row_mask:0xf bank_mask:0x3
  v_add_f32_dpp v45, v41, v41 row_ror:8 row_mask:0xf bank_mask:0x3
  s_nop 0
  v_add_f32_dpp v44, v42, v42 row_ror:8 row_mask:0xf bank_mask:0xc
  v_add_f32_dpp v45, v43, v43 row_ror:8 row_mask:0xf bank_mask:0xc
  s_nop 0
  v_add_f32_dpp v46, v44, v44 row_half_mirror row_mask:0xf bank_mask:0x5
  s_nop 1
  v_add_f32_dpp v46, v45, v45 row_half_mirror row_mask:0xf bank_mask:0xa
  s_waitcnt vmcnt(4)
  buffer_load_dwordx4 v[76:79], v3, s[8:11], s16 offen offset:3072 nt
  v_dot2_f32_bf16 v32, v96, v16, 0
  v_dot2_f32_bf16 v33, v100, v16, 0
  v_dot2_f32_bf16 v34, v104, v16, 0
  v_dot2_f32_bf16 v35, v108, v16, 0
  v_dot2c_f32_bf16 v32, v97, v17
  v_dot2c_f32_bf16 v33, v101, v17
  v_dot2c_f32_bf16 v34, v105, v17
  v_dot2c_f32_bf16 v35, v109, v17
  v_add_f32_dpp v46, v46, v46 quad_perm:[1,0,3,2] row_mask:0xf bank_mask:0xf
  s_nop 1
  v_add_f32_dpp v46, v46, v46 quad_perm:[2,3,0,1] row_mask:0xf bank_mask:0xf
  v_cvt_pk_bf16_f32 v46, 0, v46
  v_mul_f32 v46, s71, v46
  v_cvt_pk_bf16_f32 v46, 0, v46
  ds_write_b32 v12, v46 offset:32768
  v_max_f32 v8, v8, v46
  s_waitcnt vmcnt(4)
  s_add_u32 s16, s16, 32768
  s_and_b32 s16, s16, 2097151
  buffer_load_dwordx4 v[80:83], v3, s[8:11], s16 offen offset:0 nt
  v_dot2c_f32_bf16 v32, v98, v18
  v_dot2c_f32_bf16 v33, v102, v18
  v_dot2c_f32_bf16 v34, v106, v18
  v_dot2c_f32_bf16 v35, v110, v18
  v_dot2c_f32_bf16 v32, v99, v19
  v_dot2c_f32_bf16 v33, v103, v19
  v_dot2c_f32_bf16 v34, v107, v19
  v_dot2c_f32_bf16 v35, v111, v19
  s_waitcnt lgkmcnt(0)
  ds_read_b128 v[160:163], v11 offset:8192
  ds_read_b128 v[164:167], v11 offset:9216
  ds_read_b128 v[168:171], v11 offset:10240
  ds_read_b128 v[172:175], v11 offset:11264
  v_dot2_f32_bf16 v40, v144, v16, 0
  v_dot2_f32_bf16 v41, v148, v16, 0
  v_dot2_f32_bf16 v42, v152, v16, 0
  v_dot2_f32_bf16 v43, v156, v16, 0
  v_dot2c_f32_bf16 v40, v145, v17
  v_dot2c_f32_bf16 v41, v149, v17
  v_dot2c_f32_bf16 v42, v153, v17
  v_dot2c_f32_bf16 v43, v157, v17
  s_waitcnt vmcnt(4)
  buffer_load_dwordx4 v[84:87], v3, s[8:11], s16 offen offset:1024 nt
  v_add_f32_dpp v20, v32, v32 row_ror:8 row_mask:0xf bank_mask:0x3
  v_add_f32_dpp v21, v33, v33 row_ror:8 row_mask:0xf bank_mask:0x3
  s_nop 0
  v_add_f32_dpp v20, v34, v34 row_ror:8 row_mask:0xf bank_mask:0xc
  v_add_f32_dpp v21, v35, v35 row_ror:8 row_mask:0xf bank_mask:0xc
  s_nop 0
  v_add_f32_dpp v22, v20, v20 row_half_mirror row_mask:0xf bank_mask:0x5
  s_nop 1
  v_add_f32_dpp v22, v21, v21 row_half_mirror row_mask:0xf bank_mask:0xa
  v_dot2c_f32_bf16 v40, v146, v18
  v_dot2c_f32_bf16 v41, v150, v18
  v_dot2c_f32_bf16 v42, v154, v18
  v_dot2c_f32_bf16 v43, v158, v18
  v_dot2c_f32_bf16 v40, v147, v19
  v_dot2c_f32_bf16 v41, v151, v19
  v_dot2c_f32_bf16 v42, v155, v19
  v_dot2c_f32_bf16 v43, v159, v19
  s_waitcnt vmcnt(4)
  buffer_load_dwordx4 v[88:91], v3, s[8:11], s16 offen offset:2048 nt
  v_add_f32_dpp v22, v22, v22 quad_perm:[1,0,3,2] row_mask:0xf bank_mask:0xf
  s_nop 1
  v_add_f32_dpp v22, v22, v22 quad_perm:[2,3,0,1] row_mask:0xf bank_mask:0xf
  v_cvt_pk_bf16_f32 v22, 0, v22
  v_mul_f32 v22, s71, v22
  v_cvt_pk_bf16_f32 v22, 0, v22
  ds_write_b32 v9, v22 offset:32768
  v_max_f32 v8, v8, v22
  v_add_u32 v9, 64, v9
  v_add_f32_dpp v44, v40, v40 row_ror:8 row_mask:0xf bank_mask:0x3
  v_add_f32_dpp v45, v41, v41 row_ror:8 row_mask:0xf bank_mask:0x3
  s_nop 0
  v_add_f32_dpp v44, v42, v42 row_ror:8 row_mask:0xf bank_mask:0xc
  v_add_f32_dpp v45, v43, v43 row_ror:8 row_mask:0xf bank_mask:0xc
  s_nop 0
  v_add_f32_dpp v46, v44, v44 row_half_mirror row_mask:0xf bank_mask:0x5
  s_nop 1
  v_add_f32_dpp v46, v45, v45 row_half_mirror row_mask:0xf bank_mask:0xa
  s_waitcnt vmcnt(4)
  buffer_load_dwordx4 v[92:95], v3, s[8:11], s16 offen offset:3072 nt
  v_dot2_f32_bf16 v32, v112, v16, 0
  v_dot2_f32_bf16 v33, v116, v16, 0
  v_dot2_f32_bf16 v34, v120, v16, 0
  v_dot2_f32_bf16 v35, v124, v16, 0
  v_dot2c_f32_bf16 v32, v113, v17
  v_dot2c_f32_bf16 v33, v117, v17
  v_dot2c_f32_bf16 v34, v121, v17
  v_dot2c_f32_bf16 v35, v125, v17
  v_add_f32_dpp v46, v46, v46 quad_perm:[1,0,3,2] row_mask:0xf bank_mask:0xf
  s_nop 1
  v_add_f32_dpp v46, v46, v46 quad_perm:[2,3,0,1] row_mask:0xf bank_mask:0xf
  v_cvt_pk_bf16_f32 v46, 0, v46
  v_mul_f32 v46, s71, v46
  v_cvt_pk_bf16_f32 v46, 0, v46
  ds_write_b32 v12, v46 offset:32832
  v_max_f32 v8, v8, v46
  s_waitcnt vmcnt(4)
  s_add_u32 s16, s16, 32768
  s_and_b32 s16, s16, 2097151
  buffer_load_dwordx4 v[96:99], v3, s[8:11], s16 offen offset:0 nt
  v_dot2c_f32_bf16 v32, v114, v18
  v_dot2c_f32_bf16 v33, v118, v18
  v_dot2c_f32_bf16 v34, v122, v18
  v_dot2c_f32_bf16 v35, v126, v18
  v_dot2c_f32_bf16 v32, v115, v19
  v_dot2c_f32_bf16 v33, v119, v19
  v_dot2c_f32_bf16 v34, v123, v19
  v_dot2c_f32_bf16 v35, v127, v19
  s_waitcnt lgkmcnt(0)
  ds_read_b128 v[176:179], v11 offset:12288
  ds_read_b128 v[180:183], v11 offset:13312
  ds_read_b128 v[184:187], v11 offset:14336
  ds_read_b128 v[188:191], v11 offset:15360
  v_dot2_f32_bf16 v40, v160, v16, 0
  v_dot2_f32_bf16 v41, v164, v16, 0
  v_dot2_f32_bf16 v42, v168, v16, 0
  v_dot2_f32_bf16 v43, v172, v16, 0
  v_dot2c_f32_bf16 v40, v161, v17
  v_dot2c_f32_bf16 v41, v165, v17
  v_dot2c_f32_bf16 v42, v169, v17
  v_dot2c_f32_bf16 v43, v173, v17
  s_waitcnt vmcnt(4)
  buffer_load_dwordx4 v[100:103], v3, s[8:11], s16 offen offset:1024 nt
  v_add_f32_dpp v20, v32, v32 row_ror:8 row_mask:0xf bank_mask:0x3
  v_add_f32_dpp v21, v33, v33 row_ror:8 row_mask:0xf bank_mask:0x3
  s_nop 0
  v_add_f32_dpp v20, v34, v34 row_ror:8 row_mask:0xf bank_mask:0xc
  v_add_f32_dpp v21, v35, v35 row_ror:8 row_mask:0xf bank_mask:0xc
  s_nop 0
  v_add_f32_dpp v22, v20, v20 row_half_mirror row_mask:0xf bank_mask:0x5
  s_nop 1
  v_add_f32_dpp v22, v21, v21 row_half_mirror row_mask:0xf bank_mask:0xa
  v_dot2c_f32_bf16 v40, v162, v18
  v_dot2c_f32_bf16 v41, v166, v18
  v_dot2c_f32_bf16 v42, v170, v18
  v_dot2c_f32_bf16 v43, v174, v18
  v_dot2c_f32_bf16 v40, v163, v19
  v_dot2c_f32_bf16 v41, v167, v19
  v_dot2c_f32_bf16 v42, v171, v19
  v_dot2c_f32_bf16 v43, v175, v19
  s_waitcnt vmcnt(4)
  buffer_load_dwordx4 v[104:107], v3, s[8:11], s16 offen offset:2048 nt
  v_add_f32_dpp v22, v22, v22 quad_perm:[1,0,3,2] row_mask:0xf bank_mask:0xf
  s_nop 1
  v_add_f32_dpp v22, v22, v22 quad_perm:[2,3,0,1] row_mask:0xf bank_mask:0xf
  v_cvt_pk_bf16_f32 v22, 0, v22
  v_mul_f32 v22, s71, v22
  v_cvt_pk_bf16_f32 v22, 0, v22
  ds_write_b32 v9, v22 offset:32768
  v_max_f32 v8, v8, v22
  v_add_u32 v9, 64, v9
  v_add_f32_dpp v44, v40, v40 row_ror:8 row_mask:0xf bank_mask:0x3
  v_add_f32_dpp v45, v41, v41 row_ror:8 row_mask:0xf bank_mask:0x3
  s_nop 0
  v_add_f32_dpp v44, v42, v42 row_ror:8 row_mask:0xf bank_mask:0xc
  v_add_f32_dpp v45, v43, v43 row_ror:8 row_mask:0xf bank_mask:0xc
  s_nop 0
  v_add_f32_dpp v46, v44, v44 row_half_mirror row_mask:0xf bank_mask:0x5
  s_nop 1
  v_add_f32_dpp v46, v45, v45 row_half_mirror row_mask:0xf bank_mask:0xa
  s_waitcnt vmcnt(4)
  buffer_load_dwordx4 v[108:111], v3, s[8:11], s16 offen offset:3072 nt
  v_dot2_f32_bf16 v32, v64, v16, 0
  v_dot2_f32_bf16 v33, v68, v16, 0
  v_dot2_f32_bf16 v34, v72, v16, 0
  v_dot2_f32_bf16 v35, v76, v16, 0
  v_dot2c_f32_bf16 v32, v65, v17
  v_dot2c_f32_bf16 v33, v69, v17
  v_dot2c_f32_bf16 v34, v73, v17
  v_dot2c_f32_bf16 v35, v77, v17
  v_add_f32_dpp v46, v46, v46 quad_perm:[1,0,3,2] row_mask:0xf bank_mask:0xf
  s_nop 1
  v_add_f32_dpp v46, v46, v46 quad_perm:[2,3,0,1] row_mask:0xf bank_mask:0xf
  v_cvt_pk_bf16_f32 v46, 0, v46
  v_mul_f32 v46, s71, v46
  v_cvt_pk_bf16_f32 v46, 0, v46
  ds_write_b32 v12, v46 offset:32896
  v_max_f32 v8, v8, v46
  s_waitcnt vmcnt(4)
  s_add_u32 s16, s16, 32768
  s_and_b32 s16, s16, 2097151
  buffer_load_dwordx4 v[112:115], v3, s[8:11], s16 offen offset:0 nt
  v_dot2c_f32_bf16 v32, v66, v18
  v_dot2c_f32_bf16 v33, v70, v18
  v_dot2c_f32_bf16 v34, v74, v18
  v_dot2c_f32_bf16 v35, v78, v18
  v_dot2c_f32_bf16 v32, v67, v19
  v_dot2c_f32_bf16 v33, v71, v19
  v_dot2c_f32_bf16 v34, v75, v19
  v_dot2c_f32_bf16 v35, v79, v19
  s_waitcnt lgkmcnt(0)
  v_dot2_f32_bf16 v40, v176, v16, 0
  v_dot2_f32_bf16 v41, v180, v16, 0
  v_dot2_f32_bf16 v42, v184, v16, 0
  v_dot2_f32_bf16 v43, v188, v16, 0
  v_dot2c_f32_bf16 v40, v177, v17
  v_dot2c_f32_bf16 v41, v181, v17
  v_dot2c_f32_bf16 v42, v185, v17
  v_dot2c_f32_bf16 v43, v189, v17
  s_waitcnt vmcnt(4)
  buffer_load_dwordx4 v[116:119], v3, s[8:11], s16 offen offset:1024 nt
  v_add_f32_dpp v20, v32, v32 row_ror:8 row_mask:0xf bank_mask:0x3
  v_add_f32_dpp v21, v33, v33 row_ror:8 row_mask:0xf bank_mask:0x3
  s_nop 0
  v_add_f32_dpp v20, v34, v34 row_ror:8 row_mask:0xf bank_mask:0xc
  v_add_f32_dpp v21, v35, v35 row_ror:8 row_mask:0xf bank_mask:0xc
  s_nop 0
  v_add_f32_dpp v22, v20, v20 row_half_mirror row_mask:0xf bank_mask:0x5
  s_nop 1
  v_add_f32_dpp v22, v21, v21 row_half_mirror row_mask:0xf bank_mask:0xa
  v_dot2c_f32_bf16 v40, v178, v18
  v_dot2c_f32_bf16 v41, v182, v18
  v_dot2c_f32_bf16 v42, v186, v18
  v_dot2c_f32_bf16 v43, v190, v18
  v_dot2c_f32_bf16 v40, v179, v19
  v_dot2c_f32_bf16 v41, v183, v19
  v_dot2c_f32_bf16 v42, v187, v19
  v_dot2c_f32_bf16 v43, v191, v19
  s_waitcnt vmcnt(4)
  buffer_load_dwordx4 v[120:123], v3, s[8:11], s16 offen offset:2048 nt
  v_add_f32_dpp v22, v22, v22 quad_perm:[1,0,3,2] row_mask:0xf bank_mask:0xf
  s_nop 1
  v_add_f32_dpp v22, v22, v22 quad_perm:[2,3,0,1] row_mask:0xf bank_mask:0xf
  v_cvt_pk_bf16_f32 v22, 0, v22
  v_mul_f32 v22, s71, v22
  v_cvt_pk_bf16_f32 v22, 0, v22
  ds_write_b32 v9, v22 offset:32768
  v_max_f32 v8, v8, v22
  v_add_u32 v9, 64, v9
  v_add_f32_dpp v44, v40, v40 row_ror:8 row_mask:0xf bank_mask:0x3
  v_add_f32_dpp v45, v41, v41 row_ror:8 row_mask:0xf bank_mask:0x3
  s_nop 0
  v_add_f32_dpp v44, v42, v42 row_ror:8 row_mask:0xf bank_mask:0xc
  v_add_f32_dpp v45, v43, v43 row_ror:8 row_mask:0xf bank_mask:0xc
  s_nop 0
  v_add_f32_dpp v46, v44, v44 row_half_mirror row_mask:0xf bank_mask:0x5
  s_nop 1
  v_add_f32_dpp v46, v45, v45 row_half_mirror row_mask:0xf bank_mask:0xa
  s_waitcnt vmcnt(4)
  buffer_load_dwordx4 v[124:127], v3, s[8:11], s16 offen offset:3072 nt
  v_dot2_f32_bf16 v32, v80, v16, 0
  v_dot2_f32_bf16 v33, v84, v16, 0
  v_dot2_f32_bf16 v34, v88, v16, 0
  v_dot2_f32_bf16 v35, v92, v16, 0
  v_dot2c_f32_bf16 v32, v81, v17
  v_dot2c_f32_bf16 v33, v85, v17
  v_dot2c_f32_bf16 v34, v89, v17
  v_dot2c_f32_bf16 v35, v93, v17
  v_add_f32_dpp v46, v46, v46 quad_perm:[1,0,3,2] row_mask:0xf bank_mask:0xf
  s_nop 1
  v_add_f32_dpp v46, v46, v46 quad_perm:[2,3,0,1] row_mask:0xf bank_mask:0xf
  v_cvt_pk_bf16_f32 v46, 0, v46
  v_mul_f32 v46, s71, v46
  v_cvt_pk_bf16_f32 v46, 0, v46
  ds_write_b32 v12, v46 offset:32960
  v_max_f32 v8, v8, v46
  s_mov_b32 s17, 9
  s_cmp_ge_u32 s2, 28
  s_cbranch_scc1 L_loop
L_loop2:
  s_waitcnt vmcnt(7)
  s_add_u32 s16, s16, 32768
  s_and_b32 s16, s16, 2097151
  buffer_load_dwordx4 v[64:67], v3, s[8:11], s16 offen offset:0 nt
  v_dot2c_f32_bf16 v32, v82, v18
  v_dot2c_f32_bf16 v33, v86, v18
  v_dot2c_f32_bf16 v34, v90, v18
  v_dot2c_f32_bf16 v35, v94, v18
  v_dot2c_f32_bf16 v32, v83, v19
  v_dot2c_f32_bf16 v33, v87, v19
  v_dot2c_f32_bf16 v34, v91, v19
  v_dot2c_f32_bf16 v35, v95, v19
  s_waitcnt vmcnt(7)
  buffer_load_dwordx4 v[68:71], v3, s[8:11], s16 offen offset:1024 nt
  v_add_f32_dpp v20, v32, v32 row_ror:8 row_mask:0xf bank_mask:0x3
  v_add_f32_dpp v21, v33, v33 row_ror:8 row_mask:0xf bank_mask:0x3
  s_nop 0
  v_add_f32_dpp v20, v34, v34 row_ror:8 row_mask:0xf bank_mask:0xc
  v_add_f32_dpp v21, v35, v35 row_ror:8 row_mask:0xf bank_mask:0xc
  s_nop 0
  v_add_f32_dpp v22, v20, v20 row_half_mirror row_mask:0xf bank_mask:0x5
  s_nop 1
  v_add_f32_dpp v22, v21, v21 row_half_mirror row_mask:0xf bank_mask:0xa
  s_waitcnt vmcnt(7)
  buffer_load_dwordx4 v[72:75], v3, s[8:11], s16 offen offset:2048 nt
  v_add_f32_dpp v22, v22, v22 quad_perm:[1,0,3,2] row_mask:0xf bank_mask:0xf
  s_nop 1
  v_add_f32_dpp v22, v22, v22 quad_perm:[2,3,0,1] row_mask:0xf bank_mask:0xf
  v_cvt_pk_bf16_f32 v22, 0, v22
  v_mul_f32 v22, s71, v22
  v_cvt_pk_bf16_f32 v22, 0, v22
  ds_write_b32 v9, v22 offset:32768
  v_max_f32 v8, v8, v22
  v_add_u32 v9, 64, v9
  s_waitcnt vmcnt(7)
  buffer_load_dwordx4 v[76:79], v3, s[8:11], s16 offen offset:3072 nt
  v_dot2_f32_bf16 v32, v96, v16, 0
  v_dot2_f32_bf16 v33, v100, v16, 0
  v_dot2_f32_bf16 v34, v104, v16, 0
  v_dot2_f32_bf16 v35, v108, v16, 0
  v_dot2c_f32_bf16 v32, v97, v17
  v_dot2c_f32_bf16 v33, v101, v17
  v_dot2c_f32_bf16 v34, v105, v17
  v_dot2c_f32_bf16 v35, v109, v17
  s_waitcnt vmcnt(7)
  s_add_u32 s16, s16, 32768
  s_and_b32 s16, s16, 2097151
  buffer_load_dwordx4 v[80:83], v3, s[8:11], s16 offen offset:0 nt
  v_dot2c_f32_bf16 v32, v98, v18
  v_dot2c_f32_bf16 v33, v102, v18
  v_dot2c_f32_bf16 v34, v106, v18
  v_dot2c_f32_bf16 v35, v110, v18
  v_dot2c_f32_bf16 v32, v99, v19
  v_dot2c_f32_bf16 v33, v103, v19
  v_dot2c_f32_bf16 v34, v107, v19
  v_dot2c_f32_bf16 v35, v111, v19
  s_waitcnt vmcnt(7)
  buffer_load_dwordx4 v[84:87], v3, s[8:11], s16 offen offset:1024 nt
  v_add_f32_dpp v20, v32, v32 row_ror:8 row_mask:0xf bank_mask:0x3
  v_add_f32_dpp v21, v33, v33 row_ror:8 row_mask:0xf bank_mask:0x3
  s_nop 0
  v_add_f32_dpp v20, v34, v34 row_ror:8 row_mask:0xf bank_mask:0xc
  v_add_f32_dpp v21, v35, v35 row_ror:8 row_mask:0xf bank_mask:0xc
  s_nop 0
  v_add_f32_dpp v22, v20, v20 row_half_mirror row_mask:0xf bank_mask:0x5
  s_nop 1
  v_add_f32_dpp v22, v21, v21 row_half_mirror row_mask:0xf bank_mask:0xa
  s_waitcnt vmcnt(7)
  buffer_load_dwordx4 v[88:91], v3, s[8:11], s16 offen offset:2048 nt
  v_add_f32_dpp v22, v22, v22 quad_perm:[1,0,3,2] row_mask:0xf bank_mask:0xf
  s_nop 1
  v_add_f32_dpp v22, v22, v22 quad_perm:[2,3,0,1] row_mask:0xf bank_mask:0xf
  v_cvt_pk_bf16_f32 v22, 0, v22
  v_mul_f32 v22, s71, v22
  v_cvt_pk_bf16_f32 v22, 0, v22
  ds_write_b32 v9, v22 offset:32768
  v_max_f32 v8, v8, v22
  v_add_u32 v9, 64, v9
  s_waitcnt vmcnt(7)
  buffer_load_dwordx4 v[92:95], v3, s[8:11], s16 offen offset:3072 nt
  v_dot2_f32_bf16 v32, v112, v16, 0
  v_dot2_f32_bf16 v33, v116, v16, 0
  v_dot2_f32_bf16 v34, v120, v16, 0
  v_dot2_f32_bf16 v35, v124, v16, 0
  v_dot2c_f32_bf16 v32, v113, v17
  v_dot2c_f32_bf16 v33, v117, v17
  v_dot2c_f32_bf16 v34, v121, v17
  v_dot2c_f32_bf16 v35, v125, v17
  s_waitcnt vmcnt(7)
  s_add_u32 s16, s16, 32768
  s_and_b32 s16, s16, 2097151
  buffer_load_dwordx4 v[96:99], v3, s[8:11], s16 offen offset:0 nt
  v_dot2c_f32_bf16 v32, v114, v18
  v_dot2c_f32_bf16 v33, v118, v18
  v_dot2c_f32_bf16 v34, v122, v18
  v_dot2c_f32_bf16 v35, v126, v18
  v_dot2c_f32_bf16 v32, v115, v19
  v_dot2c_f32_bf16 v33, v119, v19
  v_dot2c_f32_bf16 v34, v123, v19
  v_dot2c_f32_bf16 v35, v127, v19
  s_waitcnt vmcnt(7)
  buffer_load_dwordx4 v[100:103], v3, s[8:11], s16 offen offset:1024 nt
  v_add_f32_dpp v20, v32, v32 row_ror:8 row_mask:0xf bank_mask:0x3
  v_add_f32_dpp v21, v33, v33 row_ror:8 row_mask:0xf bank_mask:0x3
  s_nop 0
  v_add_f32_dpp v20, v34, v34 row_ror:8 row_mask:0xf bank_mask:0xc
  v_add_f32_dpp v21, v35, v35 row_ror:8 row_mask:0xf bank_mask:0xc
  s_nop 0
  v_add_f32_dpp v22, v20, v20 row_half_mirror row_mask:0xf bank_mask:0x5
  s_nop 1
  v_add_f32_dpp v22, v21, v21 row_half_mirror row_mask:0xf bank_mask:0xa
  s_waitcnt vmcnt(7)
  buffer_load_dwordx4 v[104:107], v3, s[8:11], s16 offen offset:2048 nt
  v_add_f32_dpp v22, v22, v22 quad_perm:[1,0,3,2] row_mask:0xf bank_mask:0xf
  s_nop 1
  v_add_f32_dpp v22, v22, v22 quad_perm:[2,3,0,1] row_mask:0xf bank_mask:0xf
  v_cvt_pk_bf16_f32 v22, 0, v22
  v_mul_f32 v22, s71, v22
  v_cvt_pk_bf16_f32 v22, 0, v22
  ds_write_b32 v9, v22 offset:32768
  v_max_f32 v8, v8, v22
  v_add_u32 v9, 64, v9
  s_waitcnt vmcnt(7)
  buffer_load_dwordx4 v[108:111], v3, s[8:11], s16 offen offset:3072 nt
  v_dot2_f32_bf16 v32, v64, v16, 0
  v_dot2_f32_bf16 v33, v68, v16, 0
  v_dot2_f32_bf16 v34, v72, v16, 0
  v_dot2_f32_bf16 v35, v76, v16, 0
  v_dot2c_f32_bf16 v32, v65, v17
  v_dot2c_f32_bf16 v33, v69, v17
  v_dot2c_f32_bf16 v34, v73, v17
  v_dot2c_f32_bf16 v35, v77, v17
  s_waitcnt vmcnt(7)
  s_add_u32 s16, s16, 32768
  s_and_b32 s16, s16, 2097151
  buffer_load_dwordx4 v[112:115], v3, s[8:11], s16 offen offset:0 nt
  v_dot2c_f32_bf16 v32, v66, v18
  v_dot2c_f32_bf16 v33, v70, v18
  v_dot2c_f32_bf16 v34, v74, v18
  v_dot2c_f32_bf16 v35, v78, v18
  v_dot2c_f32_bf16 v32, v67, v19
  v_dot2c_f32_bf16 v33, v71, v19
  v_dot2c_f32_bf16 v34, v75, v19
  v_dot2c_f32_bf16 v35, v79, v19
  s_waitcnt vmcnt(7)
  buffer_load_dwordx4 v[116:119], v3, s[8:11], s16 offen offset:1024 nt
  v_add_f32_dpp v20, v32, v32 row_ror:8 row_mask:0xf bank_mask:0x3
  v_add_f32_dpp v21, v33, v33 row_ror:8 row_mask:0xf bank_mask:0x3
  s_nop 0
  v_add_f32_dpp v20, v34, v34 row_ror:8 row_mask:0xf bank_mask:0xc
  v_add_f32_dpp v21, v35, v35 row_ror:8 row_mask:0xf bank_mask:0xc
  s_nop 0
  v_add_f32_dpp v22, v20, v20 row_half_mirror row_mask:0xf bank_mask:0x5
  s_nop 1
  v_add_f32_dpp v22, v21, v21 row_half_mirror row_mask:0xf bank_mask:0xa
  s_waitcnt vmcnt(7)
  buffer_load_dwordx4 v[120:123], v3, s[8:11], s16 offen offset:2048 nt
  v_add_f32_dpp v22, v22, v22 quad_perm:[1,0,3,2] row_mask:0xf bank_mask:0xf
  s_nop 1
  v_add_f32_dpp v22, v22, v22 quad_perm:[2,3,0,1] row_mask:0xf bank_mask:0xf
  v_cvt_pk_bf16_f32 v22, 0, v22
  v_mul_f32 v22, s71, v22
  v_cvt_pk_bf16_f32 v22, 0, v22
  ds_write_b32 v9, v22 offset:32768
  v_max_f32 v8, v8, v22
  v_add_u32 v9, 64, v9
  s_waitcnt vmcnt(7)
  buffer_load_dwordx4 v[124:127], v3, s[8:11], s16 offen offset:3072 nt
  v_dot2_f32_bf16 v32, v80, v16, 0
  v_dot2_f32_bf16 v33, v84, v16, 0
  v_dot2_f32_bf16 v34, v88, v16, 0
  v_dot2_f32_bf16 v35, v92, v16, 0
  v_dot2c_f32_bf16 v32, v81, v17
  v_dot2c_f32_bf16 v33, v85, v17
  v_dot2c_f32_bf16 v34, v89, v17
  v_dot2c_f32_bf16 v35, v93, v17
  s_sub_u32 s17, s17, 1
  s_cmp_lg_u32 s17, 6
  s_cbranch_scc1 L_loop2
L_loop:
  s_waitcnt vmcnt(4)
  s_add_u32 s16, s16, 32768
  s_and_b32 s16, s16, 2097151
  buffer_load_dwordx4 v[64:67], v3, s[8:11], s16 offen offset:0 nt
  v_dot2c_f32_bf16 v32, v82, v18
  v_dot2c_f32_bf16 v33, v86, v18
  v_dot2c_f32_bf16 v34, v90, v18
  v_dot2c_f32_bf16 v35, v94, v18
  v_dot2c_f32_bf16 v32, v83, v19
  v_dot2c_f32_bf16 v33, v87, v19
  v_dot2c_f32_bf16 v34, v91, v19
  v_dot2c_f32_bf16 v35, v95, v19
  s_waitcnt vmcnt(4)
  buffer_load_dwordx4 v[68:71], v3, s[8:11], s16 offen offset:1024 nt
  v_add_f32_dpp v20, v32, v32 row_ror:8 row_mask:0xf bank_mask:0x3
  v_add_f32_dpp v21, v33, v33 row_ror:8 row_mask:0xf bank_mask:0x3
  s_nop 0
  v_add_f32_dpp v20, v34, v34 row_ror:8 row_mask:0xf bank_mask:0xc
  v_add_f32_dpp v21, v35, v35 row_ror:8 row_mask:0xf bank_mask:0xc
  s_nop 0
  v_add_f32_dpp v22, v20, v20 row_half_mirror row_mask:0xf bank_mask:0x5
  s_nop 1
  v_add_f32_dpp v22, v21, v21 row_half_mirror row_mask:0xf bank_mask:0xa
  s_waitcnt vmcnt(4)
  buffer_load_dwordx4 v[72:75], v3, s[8:11], s16 offen offset:2048 nt
  v_add_f32_dpp v22, v22, v22 quad_perm:[1,0,3,2] row_mask:0xf bank_mask:0xf
  s_nop 1
  v_add_f32_dpp v22, v22, v22 quad_perm:[2,3,0,1] row_mask:0xf bank_mask:0xf
  v_cvt_pk_bf16_f32 v22, 0, v22
  v_mul_f32 v22, s71, v22
  v_cvt_pk_bf16_f32 v22, 0, v22
  ds_write_b32 v9, v22 offset:32768
  v_max_f32 v8, v8, v22
  v_add_u32 v9, 64, v9
  s_waitcnt vmcnt(4)
  buffer_load_dwordx4 v[76:79], v3, s[8:11], s16 offen offset:3072 nt
  v_dot2_f32_bf16 v32, v96, v16, 0
  v_dot2_f32_bf16 v33, v100, v16, 0
  v_dot2_f32_bf16 v34, v104, v16, 0
  v_dot2_f32_bf16 v35, v108, v16, 0
  v_dot2c_f32_bf16 v32, v97, v17
  v_dot2c_f32_bf16 v33, v101, v17
  v_dot2c_f32_bf16 v34, v105, v17
  v_dot2c_f32_bf16 v35, v109, v17
  s_waitcnt vmcnt(4)
  s_add_u32 s16, s16, 32768
  s_and_b32 s16, s16, 2097151
  buffer_load_dwordx4 v[80:83], v3, s[8:11], s16 offen offset:0 nt
  v_dot2c_f32_bf16 v32, v98, v18
  v_dot2c_f32_bf16 v33, v102, v18
  v_dot2c_f32_bf16 v34, v106, v18
  v_dot2c_f32_bf16 v35, v110, v18
  v_dot2c_f32_bf16 v32, v99, v19
  v_dot2c_f32_bf16 v33, v103, v19
  v_dot2c_f32_bf16 v34, v107, v19
  v_dot2c_f32_bf16 v35, v111, v19
  s_waitcnt vmcnt(4)
  buffer_load_dwordx4 v[84:87], v3, s[8:11], s16 offen offset:1024 nt
  v_add_f32_dpp v20, v32, v32 row_ror:8 row_mask:0xf bank_mask:0x3
  v_add_f32_dpp v21, v33, v33 row_ror:8 row_mask:0xf bank_mask:0x3
  s_nop 0
  v_add_f32_dpp v20, v34, v34 row_ror:8 row_mask:0xf bank_mask:0xc
  v_add_f32_dpp v21, v35, v35 row_ror:8 row_mask:0xf bank_mask:0xc
  s_nop 0
  v_add_f32_dpp v22, v20, v20 row_half_mirror row_mask:0xf bank_mask:0x5
  s_nop 1
  v_add_f32_dpp v22, v21, v21 row_half_mirror row_mask:0xf bank_mask:0xa
  s_waitcnt vmcnt(4)
  buffer_load_dwordx4 v[88:91], v3, s[8:11], s16 offen offset:2048 nt
  v_add_f32_dpp v22, v22, v22 quad_perm:[1,0,3,2] row_mask:0xf bank_mask:0xf
  s_nop 1
  v_add_f32_dpp v22, v22, v22 quad_perm:[2,3,0,1] row_mask:0xf bank_mask:0xf
  v_cvt_pk_bf16_f32 v22, 0, v22
  v_mul_f32 v22, s71, v22
  v_cvt_pk_bf16_f32 v22, 0, v22
  ds_write_b32 v9, v22 offset:32768
  v_max_f32 v8, v8, v22
  v_add_u32 v9, 64, v9
  s_waitcnt vmcnt(4)
  buffer_load_dwordx4 v[92:95], v3, s[8:11], s16 offen offset:3072 nt
  v_dot2_f32_bf16 v32, v112, v16, 0
  v_dot2_f32_bf16 v33, v116, v16, 0
  v_dot2_f32_bf16 v34, v120, v16, 0
  v_dot2_f32_bf16 v35, v124, v16, 0
  v_dot2c_f32_bf16 v32, v113, v17
  v_dot2c_f32_bf16 v33, v117, v17
  v_dot2c_f32_bf16 v34, v121, v17
  v_dot2c_f32_bf16 v35, v125, v17
  s_waitcnt vmcnt(4)
  s_add_u32 s16, s16, 32768
  s_and_b32 s16, s16, 2097151
  buffer_load_dwordx4 v[96:99], v3, s[8:11], s16 offen offset:0 nt
  v_dot2c_f32_bf16 v32, v114, v18
  v_dot2c_f32_bf16 v33, v118, v18
  v_dot2c_f32_bf16 v34, v122, v18
  v_dot2c_f32_bf16 v35, v126, v18
  v_dot2c_f32_bf16 v32, v115, v19
  v_dot2c_f32_bf16 v33, v119, v19
  v_dot2c_f32_bf16 v34, v123, v19
  v_dot2c_f32_bf16 v35, v127, v19
  s_waitcnt vmcnt(4)
  buffer_load_dwordx4 v[100:103], v3, s[8:11], s16 offen offset:1024 nt
  v_add_f32_dpp v20, v32, v32 row_ror:8 row_mask:0xf bank_mask:0x3
  v_add_f32_dpp v21, v33, v33 row_ror:8 row_mask:0xf bank_mask:0x3
  s_nop 0
  v_add_f32_dpp v20, v34, v34 row_ror:8 row_mask:0xf bank_mask:0xc
  v_add_f32_dpp v21, v35, v35 row_ror:8 row_mask:0xf bank_mask:0xc
  s_nop 0
  v_add_f32_dpp v22, v20, v20 row_half_mirror row_mask:0xf bank_mask:0x5
  s_nop 1
  v_add_f32_dpp v22, v21, v21 row_half_mirror row_mask:0xf bank_mask:0xa
  s_waitcnt vmcnt(4)
  buffer_load_dwordx4 v[104:107], v3, s[8:11], s16 offen offset:2048 nt
  v_add_f32_dpp v22, v22, v22 quad_perm:[1,0,3,2] row_mask:0xf bank_mask:0xf
  s_nop 1
  v_add_f32_dpp v22, v22, v22 quad_perm:[2,3,0,1] row_mask:0xf bank_mask:0xf
  v_cvt_pk_bf16_f32 v22, 0, v22
  v_mul_f32 v22, s71, v22
  v_cvt_pk_bf16_f32 v22, 0, v22
  ds_write_b32 v9, v22 offset:32768
  v_max_f32 v8, v8, v22
  v_add_u32 v9, 64, v9
  s_waitcnt vmcnt(4)
  buffer_load_dwordx4 v[108:111], v3, s[8:11], s16 offen offset:3072 nt
  v_dot2_f32_bf16 v32, v64, v16, 0
  v_dot2_f32_bf16 v33, v68, v16, 0
  v_dot2_f32_bf16 v34, v72, v16, 0
  v_dot2_f32_bf16 v35, v76, v16, 0
  v_dot2c_f32_bf16 v32, v65, v17
  v_dot2c_f32_bf16 v33, v69, v17
  v_dot2c_f32_bf16 v34, v73, v17
  v_dot2c_f32_bf16 v35, v77, v17
  s_waitcnt vmcnt(4)
  s_add_u32 s16, s16, 32768
  s_and_b32 s16, s16, 2097151
  buffer_load_dwordx4 v[112:115], v3, s[8:11], s16 offen offset:0 nt
  v_dot2c_f32_bf16 v32, v66, v18
  v_dot2c_f32_bf16 v33, v70, v18
  v_dot2c_f32_bf16 v34, v74, v18
  v_dot2c_f32_bf16 v35, v78, v18
  v_dot2c_f32_bf16 v32, v67, v19
  v_dot2c_f32_bf16 v33, v71, v19
  v_dot2c_f32_bf16 v34, v75, v19
  v_dot2c_f32_bf16 v35, v79, v19
  s_waitcnt vmcnt(4)
  buffer_load_dwordx4 v[116:119], v3, s[8:11], s16 offen offset:1024 nt
  v_add_f32_dpp v20, v32, v32 row_ror:8 row_mask:0xf bank_mask:0x3
  v_add_f32_dpp v21, v33, v33 row_ror:8 row_mask:0xf bank_mask:0x3
  s_nop 0
  v_add_f32_dpp v20, v34, v34 row_ror:8 row_mask:0xf bank_mask:0xc
  v_add_f32_dpp v21, v35, v35 row_ror:8 row_mask:0xf bank_mask:0xc
  s_nop 0
  v_add_f32_dpp v22, v20, v20 row_half_mirror row_mask:0xf bank_mask:0x5
  s_nop 1
  v_add_f32_dpp v22, v21, v21 row_half_mirror row_mask:0xf bank_mask:0xa
  s_waitcnt vmcnt(4)
  buffer_load_dwordx4 v[120:123], v3, s[8:11], s16 offen offset:2048 nt
  v_add_f32_dpp v22, v22, v22 quad_perm:[1,0,3,2] row_mask:0xf bank_mask:0xf
  s_nop 1
  v_add_f32_dpp v22, v22, v22 quad_perm:[2,3,0,1] row_mask:0xf bank_mask:0xf
  v_cvt_pk_bf16_f32 v22, 0, v22
  v_mul_f32 v22, s71, v22
  v_cvt_pk_bf16_f32 v22, 0, v22
  ds_write_b32 v9, v22 offset:32768
  v_max_f32 v8, v8, v22
  v_add_u32 v9, 64, v9
  s_waitcnt vmcnt(4)
  buffer_load_dwordx4 v[124:127], v3, s[8:11], s16 offen offset:3072 nt
  v_dot2_f32_bf16 v32, v80, v16, 0
  v_dot2_f32_bf16 v33, v84, v16, 0
  v_dot2_f32_bf16 v34, v88, v16, 0
  v_dot2_f32_bf16 v35, v92, v16, 0
  v_dot2c_f32_bf16 v32, v81, v17
  v_dot2c_f32_bf16 v33, v85, v17
  v_dot2c_f32_bf16 v34, v89, v17
  v_dot2c_f32_bf16 v35, v93, v17
  s_sub_u32 s17, s17, 1
  s_cmp_lg_u32 s17, 0
  s_cbranch_scc1 L_loop
  s_memrealtime s[92:93]
  s_waitcnt vmcnt(4)
  s_add_u32 s16, s16, 32768
  s_and_b32 s16, s16, 2097151
  buffer_load_dwordx4 v[64:67], v3, s[12:15], s16 offen offset:0 nt
  v_dot2c_f32_bf16 v32, v82, v18
  v_dot2c_f32_bf16 v33, v86, v18
  v_dot2c_f32_bf16 v34, v90, v18
  v_dot2c_f32_bf16 v35, v94, v18
  v_dot2c_f32_bf16 v32, v83, v19
  v_dot2c_f32_bf16 v33, v87, v19
  v_dot2c_f32_bf16 v34, v91, v19
  v_dot2c_f32_bf16 v35, v95, v19
  v_lshlrev_b32 v26, 4, v63
  s_waitcnt vmcnt(4)
  buffer_load_dwordx4 v[68:71], v3, s[12:15], s16 offen offset:1024 nt
  v_add_f32_dpp v20, v32, v32 row_ror:8 row_mask:0xf bank_mask:0x3
  v_add_f32_dpp v21, v33, v33 row_ror:8 row_mask:0xf bank_mask:0x3
  s_nop 0
  v_add_f32_dpp v20, v34, v34 row_ror:8 row_mask:0xf bank_mask:0xc
  v_add_f32_dpp v21, v35, v35 row_ror:8 row_mask:0xf bank_mask:0xc
  s_nop 0
  v_add_f32_dpp v22, v20, v20 row_half_mirror row_mask:0xf bank_mask:0x5
  s_nop 1
  v_add_f32_dpp v22, v21, v21 row_half_mirror row_mask:0xf bank_mask:0xa
  v_mul_u32_u24 v24, 2048, v2
  s_waitcnt vmcnt(4)
  buffer_load_dwordx4 v[72:75], v3, s[12:15], s16 offen offset:2048 nt
  v_add_f32_dpp v22, v22, v22 quad_perm:[1,0,3,2] row_mask:0xf bank_mask:0xf
  s_nop 1
  v_add_f32_dpp v22, v22, v22 quad_perm:[2,3,0,1] row_mask:0xf bank_mask:0xf
  v_cvt_pk_bf16_f32 v22, 0, v22
  v_mul_f32 v22, s71, v22
  v_cvt_pk_bf16_f32 v22, 0, v22
  ds_write_b32 v9, v22 offset:32768
  v_max_f32 v8, v8, v22
  v_add_u32 v9, 64, v9
  v_add_u32 v24, v24, v26
  s_waitcnt vmcnt(4)
  buffer_load_dwordx4 v[76:79], v3, s[12:15], s16 offen offset:3072 nt
  v_dot2_f32_bf16 v32, v96, v16, 0
  v_dot2_f32_bf16 v33, v100, v16, 0
  v_dot2_f32_bf16 v34, v104, v16, 0
  v_dot2_f32_bf16 v35, v108, v16, 0
  v_dot2c_f32_bf16 v32, v97, v17
  v_dot2c_f32_bf16 v33, v101, v17
  v_dot2c_f32_bf16 v34, v105, v17
  v_dot2c_f32_bf16 v35, v109, v17
  v_lshlrev_b32 v26, 5, v63
  s_waitcnt vmcnt(4)
  s_add_u32 s16, s16, 32768
  s_and_b32 s16, s16, 2097151
  buffer_load_dwordx4 v[80:83], v3, s[12:15], s16 offen offset:0 nt
  v_dot2c_f32_bf16 v32, v98, v18
  v_dot2c_f32_bf16 v33, v102, v18
  v_dot2c_f32_bf16 v34, v106, v18
  v_dot2c_f32_bf16 v35, v110, v18
  v_dot2c_f32_bf16 v32, v99, v19
  v_dot2c_f32_bf16 v33, v103, v19
  v_dot2c_f32_bf16 v34, v107, v19
  v_dot2c_f32_bf16 v35, v111, v19
  v_lshl_add_u32 v26, v2, 13, v26
  s_waitcnt vmcnt(4)
  buffer_load_dwordx4 v[84:87], v3, s[12:15], s16 offen offset:1024 nt
  v_add_f32_dpp v20, v32, v32 row_ror:8 row_mask:0xf bank_mask:0x3
  v_add_f32_dpp v21, v33, v33 row_ror:8 row_mask:0xf bank_mask:0x3
  s_nop 0
  v_add_f32_dpp v20, v34, v34 row_ror:8 row_mask:0xf bank_mask:0xc
  v_add_f32_dpp v21, v35, v35 row_ror:8 row_mask:0xf bank_mask:0xc
  s_nop 0
  v_add_f32_dpp v22, v20, v20 row_half_mirror row_mask:0xf bank_mask:0x5
  s_nop 1
  v_add_f32_dpp v22, v21, v21 row_half_mirror row_mask:0xf bank_mask:0xa
  v_add_u32 v30, 0x20000, v26
  s_waitcnt vmcnt(4)
  buffer_load_dwordx4 v[88:91], v3, s[12:15], s16 offen offset:2048 nt
  v_add_f32_dpp v22, v22, v22 quad_perm:[1,0,3,2] row_mask:0xf bank_mask:0xf
  s_nop 1
  v_add_f32_dpp v22, v22, v22 quad_perm:[2,3,0,1] row_mask:0xf bank_mask:0xf
  v_cvt_pk_bf16_f32 v22, 0, v22
  v_mul_f32 v22, s71, v22
  v_cvt_pk_bf16_f32 v22, 0, v22
  ds_write_b32 v9, v22 offset:32768
  v_max_f32 v8, v8, v22
  v_add_u32 v9, 64, v9
  v_and_b32 v25, 1, v1
  s_waitcnt vmcnt(4)
  buffer_load_dwordx4 v[92:95], v3, s[12:15], s16 offen offset:3072 nt
  v_dot2_f32_bf16 v32, v112, v16, 0
  v_dot2_f32_bf16 v33, v116, v16, 0
  v_dot2_f32_bf16 v34, v120, v16, 0
  v_dot2_f32_bf16 v35, v124, v16, 0
  v_dot2c_f32_bf16 v32, v113, v17
  v_dot2c_f32_bf16 v33, v117, v17
  v_dot2c_f32_bf16 v34, v121, v17
  v_dot2c_f32_bf16 v35, v125, v17
  v_xor_b32 v25, v25, v2
  s_waitcnt vmcnt(4)
  s_add_u32 s16, s16, 32768
  s_and_b32 s16, s16, 2097151
  buffer_load_dwordx4 v[96:99], v3, s[12:15], s16 offen offset:0 nt
  v_dot2c_f32_bf16 v32, v114, v18
  v_dot2c_f32_bf16 v33, v118, v18
  v_dot2c_f32_bf16 v34, v122, v18
  v_dot2c_f32_bf16 v35, v126, v18
  v_dot2c_f32_bf16 v32, v115, v19
  v_dot2c_f32_bf16 v33, v119, v19
  v_dot2c_f32_bf16 v34, v123, v19
  v_dot2c_f32_bf16 v35, v127, v19
  v_lshlrev_b32 v25, 3, v25
  s_waitcnt vmcnt(4)
  buffer_load_dwordx4 v[100:103], v3, s[12:15], s16 offen offset:1024 nt
  v_add_f32_dpp v20, v32, v32 row_ror:8 row_mask:0xf bank_mask:0x3
  v_add_f32_dpp v21, v33, v33 row_ror:8 row_mask:0xf bank_mask:0x3
  s_nop 0
  v_add_f32_dpp v20, v34, v34 row_ror:8 row_mask:0xf bank_mask:0xc
  v_add_f32_dpp v21, v35, v35 row_ror:8 row_mask:0xf bank_mask:0xc
  s_nop 0
  v_add_f32_dpp v22, v20, v20 row_half_mirror row_mask:0xf bank_mask:0x5
  s_nop 1
  v_add_f32_dpp v22, v21, v21 row_half_mirror row_mask:0xf bank_mask:0xa
  s_lshl_b32 s6, s65, 6
  s_waitcnt vmcnt(4)
  buffer_load_dwordx4 v[104:107], v3, s[12:15], s16 offen offset:2048 nt
  v_add_f32_dpp v22, v22, v22 quad_perm:[1,0,3,2] row_mask:0xf bank_mask:0xf
  s_nop 1
  v_add_f32_dpp v22, v22, v22 quad_perm:[2,3,0,1] row_mask:0xf bank_mask:0xf
  v_cvt_pk_bf16_f32 v22, 0, v22
  v_mul_f32 v22, s71, v22
  v_cvt_pk_bf16_f32 v22, 0, v22
  ds_write_b32 v9, v22 offset:32768
  v_max_f32 v8, v8, v22
  v_add_u32 v9, 64, v9
  v_mov_b32 v31, s6
  s_waitcnt vmcnt(4)
  buffer_load_dwordx4 v[108:111], v3, s[12:15], s16 offen offset:3072 nt
  v_add_u32 v9, 0xfffff000, v9
  ds_read_b32 v22, v9 offset:32768
  v_max_f32_dpp v8, v8, v8 row_ror:4 row_mask:0xf bank_mask:0xf
  s_nop 1
  v_max_f32_dpp v8, v8, v8 row_ror:8 row_mask:0xf bank_mask:0xf
  v_mov_b32 v13, v8
  s_nop 1
  v_permlane16_swap_b32 v13, v8
  v_max_f32 v8, v13, v8
  v_mov_b32 v13, v8
  s_nop 1
  v_permlane32_swap_b32 v13, v8
  v_max_f32 v8, v13, v8
  ds_write_b32 v58, v8 offset:22528
  s_waitcnt lgkmcnt(0)
  v_sub_f32 v14, v22, v8
  ds_read_b32 v23, v9 offset:32832
  v_mul_f32 v14, s70, v14
  v_add_u32 v9, 64, v9
  v_exp_f32 v14, v14
  s_nop 0
  v_cvt_pk_bf16_f32 v14, v14, v14
  s_nop 1
  v_and_b32_dpp v40, v14, v4 row_newbcast:0 row_mask:0xf bank_mask:0xf
  v_and_b32_dpp v41, v14, v5 row_newbcast:0 row_mask:0xf bank_mask:0xf
  v_and_b32_dpp v42, v14, v6 row_newbcast:0 row_mask:0xf bank_mask:0xf
  v_and_b32_dpp v43, v14, v7 row_newbcast:0 row_mask:0xf bank_mask:0xf
  s_mov_b32 s17, 15
  s_waitcnt vmcnt(4)
  s_add_u32 s16, s16, 32768
  s_and_b32 s16, s16, 2097151
  buffer_load_dwordx4 v[112:115], v3, s[12:15], s16 offen offset:0 nt
  v_and_b32_dpp v44, v14, v4 row_newbcast:4 row_mask:0xf bank_mask:0xf
  v_and_b32_dpp v45, v14, v5 row_newbcast:4 row_mask:0xf bank_mask:0xf
  v_and_b32_dpp v46, v14, v6 row_newbcast:4 row_mask:0xf bank_mask:0xf
  v_and_b32_dpp v47, v14, v7 row_newbcast:4 row_mask:0xf bank_mask:0xf
  v_mfma_f32_16x16x32_bf16 v[36:39], v[40:43], v[64:67], v[36:39]
  v_and_b32_dpp v48, v14, v4 row_newbcast:8 row_mask:0xf bank_mask:0xf
  v_and_b32_dpp v49, v14, v5 row_newbcast:8 row_mask:0xf bank_mask:0xf
  v_and_b32_dpp v50, v14, v6 row_newbcast:8 row_mask:0xf bank_mask:0xf
  v_and_b32_dpp v51, v14, v7 row_newbcast:8 row_mask:0xf bank_mask:0xf
  s_mov_b32 s18, 5120
  s_waitcnt vmcnt(4)
  buffer_load_dwordx4 v[116:119], v3, s[12:15], s16 offen offset:1024 nt
  v_mfma_f32_16x16x32_bf16 v[36:39], v[44:47], v[68:71], v[36:39]
  v_and_b32_dpp v52, v14, v4 row_newbcast:12 row_mask:0xf bank_mask:0xf
  v_and_b32_dpp v53, v14, v5 row_newbcast:12 row_mask:0xf bank_mask:0xf
  v_and_b32_dpp v54, v14, v6 row_newbcast:12 row_mask:0xf bank_mask:0xf
  v_and_b32_dpp v55, v14, v7 row_newbcast:12 row_mask:0xf bank_mask:0xf
  v_mfma_f32_16x16x32_bf16 v[36:39], v[48:51], v[72:75], v[36:39]
  s_waitcnt vmcnt(4)
  buffer_load_dwordx4 v[120:123], v3, s[12:15], s16 offen offset:2048 nt
  v_mfma_f32_16x16x32_bf16 v[36:39], v[52:55], v[76:79], v[36:39]
  s_waitcnt vmcnt(4)
  buffer_load_dwordx4 v[124:127], v3, s[12:15], s16 offen offset:3072 nt
  s_waitcnt lgkmcnt(0)
  v_sub_f32 v14, v23, v8
  ds_read_b32 v22, v9 offset:32832
  v_mul_f32 v14, s70, v14
  v_add_u32 v9, 64, v9
  v_exp_f32 v14, v14
  s_nop 0
  v_cvt_pk_bf16_f32 v14, v14, v14
  s_nop 1
  v_and_b32_dpp v40, v14, v4 row_newbcast:0 row_mask:0xf bank_mask:0xf
  v_and_b32_dpp v41, v14, v5 row_newbcast:0 row_mask:0xf bank_mask:0xf
  v_and_b32_dpp v42, v14, v6 row_newbcast:0 row_mask:0xf bank_mask:0xf
  v_and_b32_dpp v43, v14, v7 row_newbcast:0 row_mask:0xf bank_mask:0xf
  s_or_b32 s4, s92, 1
  v_mov_b32 v10, s4
  ds_write_b32 v58, v10 offset:22544
  s_sub_u32 s4, s2, 32
  s_lshl_b32 s5, s4, 2
  s_add_u32 s5, s5, 16
  s_cmp_lt_u32 s4, 8
  s_cselect_b32 s5, s5, 0x1000
  v_mov_b32 v13, s5
  v_mov_b32 v15, 0x1000
  v_cmp_eq_u32 vcc, 0, v0
  s_nop 1
  v_cndmask_b32 v13, v15, v13, vcc
  buffer_store_dword v10, v13, s[28:31], 0 offen sc1
  s_mov_b32 s19, 2
L_vloop:
  s_waitcnt vmcnt(4)
  s_add_u32 s16, s16, 32768
  s_and_b32 s16, s16, 2097151
  buffer_load_dwordx4 v[64:67], v3, s[12:15], s16 offen offset:0 nt
  s_bitcmp1_b32 s18, s17
  s_cbranch_scc0 L_nobr
  s_barrier
  ds_read_b32 v10, v59 offset:22604
  s_waitcnt lgkmcnt(0)
  v_readfirstlane_b32 s19, v10
  s_nop 1
  s_add_u32 s19, s19, 2
L_nobr:
  v_and_b32_dpp v44, v14, v4 row_newbcast:4 row_mask:0xf bank_mask:0xf
  v_and_b32_dpp v45, v14, v5 row_newbcast:4 row_mask:0xf bank_mask:0xf
  v_and_b32_dpp v46, v14, v6 row_newbcast:4 row_mask:0xf bank_mask:0xf
  v_and_b32_dpp v47, v14, v7 row_newbcast:4 row_mask:0xf bank_mask:0xf
  v_mfma_f32_16x16x32_bf16 v[36:39], v[40:43], v[80:83], v[36:39]
  v_and_b32_dpp v48, v14, v4 row_newbcast:8 row_mask:0xf bank_mask:0xf
  v_and_b32_dpp v49, v14, v5 row_newbcast:8 row_mask:0xf bank_mask:0xf
  v_and_b32_dpp v50, v14, v6 row_newbcast:8 row_mask:0xf bank_mask:0xf
  v_and_b32_dpp v51, v14, v7 row_newbcast:8 row_mask:0xf bank_mask:0xf
  s_waitcnt vmcnt(4)
  buffer_load_dwordx4 v[68:71], v3, s[12:15], s16 offen offset:1024 nt
  v_mfma_f32_16x16x32_bf16 v[36:39], v[44:47], v[84:87], v[36:39]
  v_and_b32_dpp v52, v14, v4 row_newbcast:12 row_mask:0xf bank_mask:0xf
  v_and_b32_dpp v53, v14, v5 row_newbcast:12 row_mask:0xf bank_mask:0xf
  v_and_b32_dpp v54, v14, v6 row_newbcast:12 row_mask:0xf bank_mask:0xf
  v_and_b32_dpp v55, v14, v7 row_newbcast:12 row_mask:0xf bank_mask:0xf
  v_mfma_f32_16x16x32_bf16 v[36:39], v[48:51], v[88:91], v[36:39]
  s_waitcnt vmcnt(4)
  buffer_load_dwordx4 v[72:75], v3, s[12:15], s16 offen offset:2048 nt
  v_mfma_f32_16x16x32_bf16 v[36:39], v[52:55], v[92:95], v[36:39]
  s_waitcnt vmcnt(4)
  buffer_load_dwordx4 v[76:79], v3, s[12:15], s16 offen offset:3072 nt
  s_waitcnt lgkmcnt(0)
  v_sub_f32 v14, v22, v8
  ds_read_b32 v23, v9 offset:32832
  v_mul_f32 v14, s70, v14
  v_add_u32 v9, 64, v9
  v_exp_f32 v14, v14
  s_nop 0
  v_cvt_pk_bf16_f32 v14, v14, v14
  s_nop 1
  v_and_b32_dpp v40, v14, v4 row_newbcast:0 row_mask:0xf bank_mask:0xf
  v_and_b32_dpp v41, v14, v5 row_newbcast:0 row_mask:0xf bank_mask:0xf
  v_and_b32_dpp v42, v14, v6 row_newbcast:0 row_mask:0xf bank_mask:0xf
  v_and_b32_dpp v43, v14, v7 row_newbcast:0 row_mask:0xf bank_mask:0xf
  s_waitcnt vmcnt(4)
  s_add_u32 s16, s16, 32768
  s_and_b32 s16, s16, 2097151
  buffer_load_dwordx4 v[80:83], v3, s[12:15], s16 offen offset:0 nt
  v_and_b32_dpp v44, v14, v4 row_newbcast:4 row_mask:0xf bank_mask:0xf
  v_and_b32_dpp v45, v14, v5 row_newbcast:4 row_mask:0xf bank_mask:0xf
  v_and_b32_dpp v46, v14, v6 row_newbcast:4 row_mask:0xf bank_mask:0xf
  v_and_b32_dpp v47, v14, v7 row_newbcast:4 row_mask:0xf bank_mask:0xf
  v_mfma_f32_16x16x32_bf16 v[36:39], v[40:43], v[96:99], v[36:39]
  v_and_b32_dpp v48, v14, v4 row_newbcast:8 row_mask:0xf bank_mask:0xf
  v_and_b32_dpp v49, v14, v5 row_newbcast:8 row_mask:0xf bank_mask:0xf
  v_and_b32_dpp v50, v14, v6 row_newbcast:8 row_mask:0xf bank_mask:0xf
  v_and_b32_dpp v51, v14, v7 row_newbcast:8 row_mask:0xf bank_mask:0xf
  s_waitcnt vmcnt(4)
  buffer_load_dwordx4 v[84:87], v3, s[12:15], s16 offen offset:1024 nt
  v_mfma_f32_16x16x32_bf16 v[36:39], v[44:47], v[100:103], v[36:39]
  v_and_b32_dpp v52, v14, v4 row_newbcast:12 row_mask:0xf bank_mask:0xf
  v_and_b32_dpp v53, v14, v5 row_newbcast:12 row_mask:0xf bank_mask:0xf
  v_and_b32_dpp v54, v14, v6 row_newbcast:12 row_mask:0xf bank_mask:0xf
  v_and_b32_dpp v55, v14, v7 row_newbcast:12 row_mask:0xf bank_mask:0xf
  v_mfma_f32_16x16x32_bf16 v[36:39], v[48:51], v[104:107], v[36:39]
  s_waitcnt vmcnt(4)
  buffer_load_dwordx4 v[88:91], v3, s[12:15], s16 offen offset:2048 nt
  v_mfma_f32_16x16x32_bf16 v[36:39], v[52:55], v[108:111], v[36:39]
  s_waitcnt vmcnt(4)
  buffer_load_dwordx4 v[92:95], v3, s[12:15], s16 offen offset:3072 nt
  s_waitcnt lgkmcnt(0)
  v_sub_f32 v14, v23, v8
  ds_read_b32 v22, v9 offset:32832
  v_mul_f32 v14, s70, v14
  v_add_u32 v9, 64, v9
  v_exp_f32 v14, v14
  s_nop 0
  v_cvt_pk_bf16_f32 v14, v14, v14
  s_nop 1
  v_and_b32_dpp v40, v14, v4 row_newbcast:0 row_mask:0xf bank_mask:0xf
  v_and_b32_dpp v41, v14, v5 row_newbcast:0 row_mask:0xf bank_mask:0xf
  v_and_b32_dpp v42, v14, v6 row_newbcast:0 row_mask:0xf bank_mask:0xf
  v_and_b32_dpp v43, v14, v7 row_newbcast:0 row_mask:0xf bank_mask:0xf
  s_waitcnt vmcnt(4)
  s_add_u32 s16, s16, 32768
  s_and_b32 s16, s16, 2097151
  buffer_load_dwordx4 v[96:99], v3, s[12:15], s16 offen offset:0 nt
  v_and_b32_dpp v44, v14, v4 row_newbcast:4 row_mask:0xf bank_mask:0xf
  v_and_b32_dpp v45, v14, v5 row_newbcast:4 row_mask:0xf bank_mask:0xf
  v_and_b32_dpp v46, v14, v6 row_newbcast:4 row_mask:0xf bank_mask:0xf
  v_and_b32_dpp v47, v14, v7 row_newbcast:4 row_mask:0xf bank_mask:0xf
  v_mfma_f32_16x16x32_bf16 v[36:39], v[40:43], v[112:115], v[36:39]
  v_and_b32_dpp v48, v14, v4 row_newbcast:8 row_mask:0xf bank_mask:0xf
  v_and_b32_dpp v49, v14, v5 row_newbcast:8 row_mask:0xf bank_mask:0xf
  v_and_b32_dpp v50, v14, v6 row_newbcast:8 row_mask:0xf bank_mask:0xf
  v_and_b32_dpp v51, v14, v7 row_newbcast:8 row_mask:0xf bank_mask:0xf
  s_waitcnt vmcnt(4)
  buffer_load_dwordx4 v[100:103], v3, s[12:15], s16 offen offset:1024 nt
  v_mfma_f32_16x16x32_bf16 v[36:39], v[44:47], v[116:119], v[36:39]
  v_and_b32_dpp v52, v14, v4 row_newbcast:12 row_mask:0xf bank_mask:0xf
  v_and_b32_dpp v53, v14, v5 row_newbcast:12 row_mask:0xf bank_mask:0xf
  v_and_b32_dpp v54, v14, v6 row_newbcast:12 row_mask:0xf bank_mask:0xf
  v_and_b32_dpp v55, v14, v7 row_newbcast:12 row_mask:0xf bank_mask:0xf
  v_mfma_f32_16x16x32_bf16 v[36:39], v[48:51], v[120:123], v[36:39]
  s_waitcnt vmcnt(4)
  buffer_load_dwordx4 v[104:107], v3, s[12:15], s16 offen offset:2048 nt
  v_mfma_f32_16x16x32_bf16 v[36:39], v[52:55], v[124:127], v[36:39]
  s_waitcnt vmcnt(4)
  buffer_load_dwordx4 v[108:111], v3, s[12:15], s16 offen offset:3072 nt
  s_waitcnt lgkmcnt(0)
  v_sub_f32 v14, v22, v8
  ds_read_b32 v23, v9 offset:32832
  v_mul_f32 v14, s70, v14
  v_add_u32 v9, 64, v9
  v_exp_f32 v14, v14
  s_nop 0
  v_cvt_pk_bf16_f32 v14, v14, v14
  s_nop 1
  v_and_b32_dpp v40, v14, v4 row_newbcast:0 row_mask:0xf bank_mask:0xf
  v_and_b32_dpp v41, v14, v5 row_newbcast:0 row_mask:0xf bank_mask:0xf
  v_and_b32_dpp v42, v14, v6 row_newbcast:0 row_mask:0xf bank_mask:0xf
  v_and_b32_dpp v43, v14, v7 row_newbcast:0 row_mask:0xf bank_mask:0xf
  s_waitcnt vmcnt(4)
  s_add_u32 s16, s16, 32768
  s_and_b32 s16, s16, 2097151
  buffer_load_dwordx4 v[112:115], v3, s[12:15], s16 offen offset:0 nt
  v_and_b32_dpp v44, v14, v4 row_newbcast:4 row_mask:0xf bank_mask:0xf
  v_and_b32_dpp v45, v14, v5 row_newbcast:4 row_mask:0xf bank_mask:0xf
  v_and_b32_dpp v46, v14, v6 row_newbcast:4 row_mask:0xf bank_mask:0xf
  v_and_b32_dpp v47, v14, v7 row_newbcast:4 row_mask:0xf bank_mask:0xf
  v_mfma_f32_16x16x32_bf16 v[36:39], v[40:43], v[64:67], v[36:39]
  v_and_b32_dpp v48, v14, v4 row_newbcast:8 row_mask:0xf bank_mask:0xf
  v_and_b32_dpp v49, v14, v5 row_newbcast:8 row_mask:0xf bank_mask:0xf
  v_and_b32_dpp v50, v14, v6 row_newbcast:8 row_mask:0xf bank_mask:0xf
  v_and_b32_dpp v51, v14, v7 row_newbcast:8 row_mask:0xf bank_mask:0xf
  s_waitcnt vmcnt(4)
  buffer_load_dwordx4 v[116:119], v3, s[12:15], s16 offen offset:1024 nt
  v_mfma_f32_16x16x32_bf16 v[36:39], v[44:47], v[68:71], v[36:39]
  v_and_b32_dpp v52, v14, v4 row_newbcast:12 row_mask:0xf bank_mask:0xf
  v_and_b32_dpp v53, v14, v5 row_newbcast:12 row_mask:0xf bank_mask:0xf
  v_and_b32_dpp v54, v14, v6 row_newbcast:12 row_mask:0xf bank_mask:0xf
  v_and_b32_dpp v55, v14, v7 row_newbcast:12 row_mask:0xf bank_mask:0xf
  v_mfma_f32_16x16x32_bf16 v[36:39], v[48:51], v[72:75], v[36:39]
  s_waitcnt vmcnt(4)
  buffer_load_dwordx4 v[120:123], v3, s[12:15], s16 offen offset:2048 nt
  v_mfma_f32_16x16x32_bf16 v[36:39], v[52:55], v[76:79], v[36:39]
  s_waitcnt vmcnt(4)
  buffer_load_dwordx4 v[124:127], v3, s[12:15], s16 offen offset:3072 nt
  s_waitcnt lgkmcnt(0)
  v_sub_f32 v14, v23, v8
  ds_read_b32 v22, v9 offset:32832
  v_mul_f32 v14, s70, v14
  v_add_u32 v9, 64, v9
  v_exp_f32 v14, v14
  s_nop 0
  v_cvt_pk_bf16_f32 v14, v14, v14
  s_nop 1
  v_and_b32_dpp v40, v14, v4 row_newbcast:0 row_mask:0xf bank_mask:0xf
  v_and_b32_dpp v41, v14, v5 row_newbcast:0 row_mask:0xf bank_mask:0xf
  v_and_b32_dpp v42, v14, v6 row_newbcast:0 row_mask:0xf bank_mask:0xf
  v_and_b32_dpp v43, v14, v7 row_newbcast:0 row_mask:0xf bank_mask:0xf
  s_sub_u32 s17, s17, 1
  s_cmp_lg_u32 s17, s19
  s_cbranch_scc1 L_vloop
L_vloop3:
  s_waitcnt vmcnt(7)
  s_add_u32 s16, s16, 32768
  s_and_b32 s16, s16, 2097151
  buffer_load_dwordx4 v[64:67], v3, s[12:15], s16 offen offset:0 nt
  v_and_b32_dpp v44, v14, v4 row_newbcast:4 row_mask:0xf bank_mask:0xf
  v_and_b32_dpp v45, v14, v5 row_newbcast:4 row_mask:0xf bank_mask:0xf
  v_and_b32_dpp v46, v14, v6 row_newbcast:4 row_mask:0xf bank_mask:0xf
  v_and_b32_dpp v47, v14, v7 row_newbcast:4 row_mask:0xf bank_mask:0xf
  v_mfma_f32_16x16x32_bf16 v[36:39], v[40:43], v[80:83], v[36:39]
  v_and_b32_dpp v48, v14, v4 row_newbcast:8 row_mask:0xf bank_mask:0xf
  v_and_b32_dpp v49, v14, v5 row_newbcast:8 row_mask:0xf bank_mask:0xf
  v_and_b32_dpp v50, v14, v6 row_newbcast:8 row_mask:0xf bank_mask:0xf
  v_and_b32_dpp v51, v14, v7 row_newbcast:8 row_mask:0xf bank_mask:0xf
  s_waitcnt vmcnt(7)
  buffer_load_dwordx4 v[68:71], v3, s[12:15], s16 offen offset:1024 nt
  v_mfma_f32_16x16x32_bf16 v[36:39], v[44:47], v[84:87], v[36:39]
  v_and_b32_dpp v52, v14, v4 row_newbcast:12 row_mask:0xf bank_mask:0xf
  v_and_b32_dpp v53, v14, v5 row_newbcast:12 row_mask:0xf bank_mask:0xf
  v_and_b32_dpp v54, v14, v6 row_newbcast:12 row_mask:0xf bank_mask:0xf
  v_and_b32_dpp v55, v14, v7 row_newbcast:12 row_mask:0xf bank_mask:0xf
  v_mfma_f32_16x16x32_bf16 v[36:39], v[48:51], v[88:91], v[36:39]
  s_waitcnt vmcnt(7)
  buffer_load_dwordx4 v[72:75], v3, s[12:15], s16 offen offset:2048 nt
  v_mfma_f32_16x16x32_bf16 v[36:39], v[52:55], v[92:95], v[36:39]
  s_waitcnt vmcnt(7)
  buffer_load_dwordx4 v[76:79], v3, s[12:15], s16 offen offset:3072 nt
  s_waitcnt lgkmcnt(0)
  v_sub_f32 v14, v22, v8
  ds_read_b32 v23, v9 offset:32832
  v_mul_f32 v14, s70, v14
  v_add_u32 v9, 64, v9
  v_exp_f32 v14, v14
  s_nop 0
  v_cvt_pk_bf16_f32 v14, v14, v14
  s_nop 1
  v_and_b32_dpp v40, v14, v4 row_newbcast:0 row_mask:0xf bank_mask:0xf
  v_and_b32_dpp v41, v14, v5 row_newbcast:0 row_mask:0xf bank_mask:0xf
  v_and_b32_dpp v42, v14, v6 row_newbcast:0 row_mask:0xf bank_mask:0xf
  v_and_b32_dpp v43, v14, v7 row_newbcast:0 row_mask:0xf bank_mask:0xf
  s_waitcnt vmcnt(7)
  s_add_u32 s16, s16, 32768
  s_and_b32 s16, s16, 2097151
  buffer_load_dwordx4 v[80:83], v3, s[12:15], s16 offen offset:0 nt
  v_and_b32_dpp v44, v14, v4 row_newbcast:4 row_mask:0xf bank_mask:0xf
  v_and_b32_dpp v45, v14, v5 row_newbcast:4 row_mask:0xf bank_mask:0xf
  v_and_b32_dpp v46, v14, v6 row_newbcast:4 row_mask:0xf bank_mask:0xf
  v_and_b32_dpp v47, v14, v7 row_newbcast:4 row_mask:0xf bank_mask:0xf
  v_mfma_f32_16x16x32_bf16 v[36:39], v[40:43], v[96:99], v[36:39]
  v_and_b32_dpp v48, v14, v4 row_newbcast:8 row_mask:0xf bank_mask:0xf
  v_and_b32_dpp v49, v14, v5 row_newbcast:8 row_mask:0xf bank_mask:0xf
  v_and_b32_dpp v50, v14, v6 row_newbcast:8 row_mask:0xf bank_mask:0xf
  v_and_b32_dpp v51, v14, v7 row_newbcast:8 row_mask:0xf bank_mask:0xf
  s_waitcnt vmcnt(7)
  buffer_load_dwordx4 v[84:87], v3, s[12:15], s16 offen offset:1024 nt
  v_mfma_f32_16x16x32_bf16 v[36:39], v[44:47], v[100:103], v[36:39]
  v_and_b32_dpp v52, v14, v4 row_newbcast:12 row_mask:0xf bank_mask:0xf
  v_and_b32_dpp v53, v14, v5 row_newbcast:12 row_mask:0xf bank_mask:0xf
  v_and_b32_dpp v54, v14, v6 row_newbcast:12 row_mask:0xf bank_mask:0xf
  v_and_b32_dpp v55, v14, v7 row_newbcast:12 row_mask:0xf bank_mask:0xf
  v_mfma_f32_16x16x32_bf16 v[36:39], v[48:51], v[104:107], v[36:39]
  s_waitcnt vmcnt(7)
  buffer_load_dwordx4 v[88:91], v3, s[12:15], s16 offen offset:2048 nt
  v_mfma_f32_16x16x32_bf16 v[36:39], v[52:55], v[108:111], v[36:39]
  s_waitcnt vmcnt(7)
  buffer_load_dwordx4 v[92:95], v3, s[12:15], s16 offen offset:3072 nt
  s_waitcnt lgkmcnt(0)
  v_sub_f32 v14, v23, v8
  ds_read_b32 v22, v9 offset:32832
  v_mul_f32 v14, s70, v14
  v_add_u32 v9, 64, v9
  v_exp_f32 v14, v14
  s_nop 0
  v_cvt_pk_bf16_f32 v14, v14, v14
  s_nop 1
  v_and_b32_dpp v40, v14, v4 row_newbcast:0 row_mask:0xf bank_mask:0xf
  v_and_b32_dpp v41, v14, v5 row_newbcast:0 row_mask:0xf bank_mask:0xf
  v_and_b32_dpp v42, v14, v6 row_newbcast:0 row_mask:0xf bank_mask:0xf
  v_and_b32_dpp v43, v14, v7 row_newbcast:0 row_mask:0xf bank_mask:0xf
  s_waitcnt vmcnt(7)
  s_add_u32 s16, s16, 32768
  s_and_b32 s16, s16, 2097151
  buffer_load_dwordx4 v[96:99], v3, s[12:15], s16 offen offset:0 nt
  v_and_b32_dpp v44, v14, v4 row_newbcast:4 row_mask:0xf bank_mask:0xf
  v_and_b32_dpp v45, v14, v5 row_newbcast:4 row_mask:0xf bank_mask:0xf
  v_and_b32_dpp v46, v14, v6 row_newbcast:4 row_mask:0xf bank_mask:0xf
  v_and_b32_dpp v47, v14, v7 row_newbcast:4 row_mask:0xf bank_mask:0xf
  v_mfma_f32_16x16x32_bf16 v[36:39], v[40:43], v[112:115], v[36:39]
  v_and_b32_dpp v48, v14, v4 row_newbcast:8 row_mask:0xf bank_mask:0xf
  v_and_b32_dpp v49, v14, v5 row_newbcast:8 row_mask:0xf bank_mask:0xf
  v_and_b32_dpp v50, v14, v6 row_newbcast:8 row_mask:0xf bank_mask:0xf
  v_and_b32_dpp v51, v14, v7 row_newbcast:8 row_mask:0xf bank_mask:0xf
  s_waitcnt vmcnt(7)
  buffer_load_dwordx4 v[100:103], v3, s[12:15], s16 offen offset:1024 nt
  v_mfma_f32_16x16x32_bf16 v[36:39], v[44:47], v[116:119], v[36:39]
  v_and_b32_dpp v52, v14, v4 row_newbcast:12 row_mask:0xf bank_mask:0xf
  v_and_b32_dpp v53, v14, v5 row_newbcast:12 row_mask:0xf bank_mask:0xf
  v_and_b32_dpp v54, v14, v6 row_newbcast:12 row_mask:0xf bank_mask:0xf
  v_and_b32_dpp v55, v14, v7 row_newbcast:12 row_mask:0xf bank_mask:0xf
  v_mfma_f32_16x16x32_bf16 v[36:39], v[48:51], v[120:123], v[36:39]
  s_waitcnt vmcnt(7)
  buffer_load_dwordx4 v[104:107], v3, s[12:15], s16 offen offset:2048 nt
  v_mfma_f32_16x16x32_bf16 v[36:39], v[52:55], v[124:127], v[36:39]
  s_waitcnt vmcnt(7)
  buffer_load_dwordx4 v[108:111], v3, s[12:15], s16 offen offset:3072 nt
  s_waitcnt lgkmcnt(0)
  v_sub_f32 v14, v22, v8
  ds_read_b32 v23, v9 offset:32832
  v_mul_f32 v14, s70, v14
  v_add_u32 v9, 64, v9
  v_exp_f32 v14, v14
  s_nop 0
  v_cvt_pk_bf16_f32 v14, v14, v14
  s_nop 1
  v_and_b32_dpp v40, v14, v4 row_newbcast:0 row_mask:0xf bank_mask:0xf
  v_and_b32_dpp v41, v14, v5 row_newbcast:0 row_mask:0xf bank_mask:0xf
  v_and_b32_dpp v42, v14, v6 row_newbcast:0 row_mask:0xf bank_mask:0xf
  v_and_b32_dpp v43, v14, v7 row_newbcast:0 row_mask:0xf bank_mask:0xf
  s_waitcnt vmcnt(7)
  s_add_u32 s16, s16, 32768
  s_and_b32 s16, s16, 2097151
  buffer_load_dwordx4 v[112:115], v3, s[12:15], s16 offen offset:0 nt
  v_and_b32_dpp v44, v14, v4 row_newbcast:4 row_mask:0xf bank_mask:0xf
  v_and_b32_dpp v45, v14, v5 row_newbcast:4 row_mask:0xf bank_mask:0xf
  v_and_b32_dpp v46, v14, v6 row_newbcast:4 row_mask:0xf bank_mask:0xf
  v_and_b32_dpp v47, v14, v7 row_newbcast:4 row_mask:0xf bank_mask:0xf
  v_mfma_f32_16x16x32_bf16 v[36:39], v[40:43], v[64:67], v[36:39]
  v_and_b32_dpp v48, v14, v4 row_newbcast:8 row_mask:0xf bank_mask:0xf
  v_and_b32_dpp v49, v14, v5 row_newbcast:8 row_mask:0xf bank_mask:0xf
  v_and_b32_dpp v50, v14, v6 row_newbcast:8 row_mask:0xf bank_mask:0xf
  v_and_b32_dpp v51, v14, v7 row_newbcast:8 row_mask:0xf bank_mask:0xf
  s_waitcnt vmcnt(7)
  buffer_load_dwordx4 v[116:119], v3, s[12:15], s16 offen offset:1024 nt
  v_mfma_f32_16x16x32_bf16 v[36:39], v[44:47], v[68:71], v[36:39]
  v_and_b32_dpp v52, v14, v4 row_newbcast:12 row_mask:0xf bank_mask:0xf
  v_and_b32_dpp v53, v14, v5 row_newbcast:12 row_mask:0xf bank_mask:0xf
  v_and_b32_dpp v54, v14, v6 row_newbcast:12 row_mask:0xf bank_mask:0xf
  v_and_b32_dpp v55, v14, v7 row_newbcast:12 row_mask:0xf bank_mask:0xf
  v_mfma_f32_16x16x32_bf16 v[36:39], v[48:51], v[72:75], v[36:39]
  s_waitcnt vmcnt(7)
  buffer_load_dwordx4 v[120:123], v3, s[12:15], s16 offen offset:2048 nt
  v_mfma_f32_16x16x32_bf16 v[36:39], v[52:55], v[76:79], v[36:39]
  s_waitcnt vmcnt(7)
  buffer_load_dwordx4 v[124:127], v3, s[12:15], s16 offen offset:3072 nt
  s_waitcnt lgkmcnt(0)
  v_sub_f32 v14, v23, v8
  ds_read_b32 v22, v9 offset:32832
  v_mul_f32 v14, s70, v14
  v_add_u32 v9, 64, v9
  v_exp_f32 v14, v14
  s_nop 0
  v_cvt_pk_bf16_f32 v14, v14, v14
  s_nop 1
  v_and_b32_dpp v40, v14, v4 row_newbcast:0 row_mask:0xf bank_mask:0xf
  v_and_b32_dpp v41, v14, v5 row_newbcast:0 row_mask:0xf bank_mask:0xf
  v_and_b32_dpp v42, v14, v6 row_newbcast:0 row_mask:0xf bank_mask:0xf
  v_and_b32_dpp v43, v14, v7 row_newbcast:0 row_mask:0xf bank_mask:0xf
  s_sub_u32 s17, s17, 1
  s_cmp_lg_u32 s17, 0
  s_cbranch_scc1 L_vloop3
  buffer_atomic_add v62, v61, s[28:31], 0 offen sc0 sc1
  v_and_b32_dpp v44, v14, v4 row_newbcast:4 row_mask:0xf bank_mask:0xf
  v_and_b32_dpp v45, v14, v5 row_newbcast:4 row_mask:0xf bank_mask:0xf
  v_and_b32_dpp v46, v14, v6 row_newbcast:4 row_mask:0xf bank_mask:0xf
  v_and_b32_dpp v47, v14, v7 row_newbcast:4 row_mask:0xf bank_mask:0xf
  v_mfma_f32_16x16x32_bf16 v[36:39], v[40:43], v[80:83], v[36:39]
  v_and_b32_dpp v48, v14, v4 row_newbcast:8 row_mask:0xf bank_mask:0xf
  v_and_b32_dpp v49, v14, v5 row_newbcast:8 row_mask:0xf bank_mask:0xf
  v_and_b32_dpp v50, v14, v6 row_newbcast:8 row_mask:0xf bank_mask:0xf
  v_and_b32_dpp v51, v14, v7 row_newbcast:8 row_mask:0xf bank_mask:0xf
  v_mfma_f32_16x16x32_bf16 v[36:39], v[44:47], v[84:87], v[36:39]
  v_and_b32_dpp v52, v14, v4 row_newbcast:12 row_mask:0xf bank_mask:0xf
  v_and_b32_dpp v53, v14, v5 row_newbcast:12 row_mask:0xf bank_mask:0xf
  v_and_b32_dpp v54, v14, v6 row_newbcast:12 row_mask:0xf bank_mask:0xf
  v_and_b32_dpp v55, v14, v7 row_newbcast:12 row_mask:0xf bank_mask:0xf
  v_mfma_f32_16x16x32_bf16 v[36:39], v[48:51], v[88:91], v[36:39]
  s_nop 0
  v_mfma_f32_16x16x32_bf16 v[36:39], v[52:55], v[92:95], v[36:39]
  s_waitcnt lgkmcnt(0)
  v_sub_f32 v14, v22, v8
  ds_read_b32 v23, v9 offset:32832
  v_mul_f32 v14, s70, v14
  v_add_u32 v9, 64, v9
  v_exp_f32 v14, v14
  s_nop 0
  v_cvt_pk_bf16_f32 v14, v14, v14
  s_nop 1
  v_and_b32_dpp v40, v14, v4 row_newbcast:0 row_mask:0xf bank_mask:0xf
  v_and_b32_dpp v41, v14, v5 row_newbcast:0 row_mask:0xf bank_mask:0xf
  v_and_b32_dpp v42, v14, v6 row_newbcast:0 row_mask:0xf bank_mask:0xf
  v_and_b32_dpp v43, v14, v7 row_newbcast:0 row_mask:0xf bank_mask:0xf
  v_and_b32_dpp v44, v14, v4 row_newbcast:4 row_mask:0xf bank_mask:0xf
  v_and_b32_dpp v45, v14, v5 row_newbcast:4 row_mask:0xf bank_mask:0xf
  v_and_b32_dpp v46, v14, v6 row_newbcast:4 row_mask:0xf bank_mask:0xf
  v_and_b32_dpp v47, v14, v7 row_newbcast:4 row_mask:0xf bank_mask:0xf
  s_waitcnt vmcnt(8)
  v_mfma_f32_16x16x32_bf16 v[36:39], v[40:43], v[96:99], v[36:39]
  v_and_b32_dpp v48, v14, v4 row_newbcast:8 row_mask:0xf bank_mask:0xf
  v_and_b32_dpp v49, v14, v5 row_newbcast:8 row_mask:0xf bank_mask:0xf
  v_and_b32_dpp v50, v14, v6 row_newbcast:8 row_mask:0xf bank_mask:0xf
  v_and_b32_dpp v51, v14, v7 row_newbcast:8 row_mask:0xf bank_mask:0xf
  s_waitcnt vmcnt(7)
  v_mfma_f32_16x16x32_bf16 v[36:39], v[44:47], v[100:103], v[36:39]
  v_and_b32_dpp v52, v14, v4 row_newbcast:12 row_mask:0xf bank_mask:0xf
  v_and_b32_dpp v53, v14, v5 row_newbcast:12 row_mask:0xf bank_mask:0xf
  v_and_b32_dpp v54, v14, v6 row_newbcast:12 row_mask:0xf bank_mask:0xf
  v_and_b32_dpp v55, v14, v7 row_newbcast:12 row_mask:0xf bank_mask:0xf
  s_waitcnt vmcnt(6)
  v_mfma_f32_16x16x32_bf16 v[36:39], v[48:51], v[104:107], v[36:39]
  s_waitcnt vmcnt(5)
  v_mfma_f32_16x16x32_bf16 v[36:39], v[52:55], v[108:111], v[36:39]
  s_waitcnt lgkmcnt(0)
  v_sub_f32 v14, v23, v8
  ds_read_b32 v22, v9 offset:32832
  v_mul_f32 v14, s70, v14
  v_add_u32 v9, 64, v9
  v_exp_f32 v14, v14
  s_nop 0
  v_cvt_pk_bf16_f32 v14, v14, v14
  s_nop 1
  v_and_b32_dpp v40, v14, v4 row_newbcast:0 row_mask:0xf bank_mask:0xf
  v_and_b32_dpp v41, v14, v5 row_newbcast:0 row_mask:0xf bank_mask:0xf
  v_and_b32_dpp v42, v14, v6 row_newbcast:0 row_mask:0xf bank_mask:0xf
  v_and_b32_dpp v43, v14, v7 row_newbcast:0 row_mask:0xf bank_mask:0xf
  v_and_b32_dpp v44, v14, v4 row_newbcast:4 row_mask:0xf bank_mask:0xf
  v_and_b32_dpp v45, v14, v5 row_newbcast:4 row_mask:0xf bank_mask:0xf
  v_and_b32_dpp v46, v14, v6 row_newbcast:4 row_mask:0xf bank_mask:0xf
  v_and_b32_dpp v47, v14, v7 row_newbcast:4 row_mask:0xf bank_mask:0xf
  s_waitcnt vmcnt(4)
  v_mfma_f32_16x16x32_bf16 v[36:39], v[40:43], v[112:115], v[36:39]
  v_and_b32_dpp v48, v14, v4 row_newbcast:8 row_mask:0xf bank_mask:0xf
  v_and_b32_dpp v49, v14, v5 row_newbcast:8 row_mask:0xf bank_mask:0xf
  v_and_b32_dpp v50, v14, v6 row_newbcast:8 row_mask:0xf bank_mask:0xf
  v_and_b32_dpp v51, v14, v7 row_newbcast:8 row_mask:0xf bank_mask:0xf
  s_waitcnt vmcnt(3)
  v_mfma_f32_16x16x32_bf16 v[36:39], v[44:47], v[116:119], v[36:39]
  v_and_b32_dpp v52, v14, v4 row_newbcast:12 row_mask:0xf bank_mask:0xf
  v_and_b32_dpp v53, v14, v5 row_newbcast:12 row_mask:0xf bank_mask:0xf
  v_and_b32_dpp v54, v14, v6 row_newbcast:12 row_mask:0xf bank_mask:0xf
  v_and_b32_dpp v55, v14, v7 row_newbcast:12 row_mask:0xf bank_mask:0xf
  s_waitcnt vmcnt(2)
  v_mfma_f32_16x16x32_bf16 v[36:39], v[48:51], v[120:123], v[36:39]
  s_waitcnt vmcnt(1)
  v_mfma_f32_16x16x32_bf16 v[36:39], v[52:55], v[124:127], v[36:39]
  s_nop 7
  v_cvt_pk_bf16_f32 v36, v36, v37
  v_cvt_pk_bf16_f32 v37, v38, v39
  ds_write_b64 v57, v[36:37] offset:20480
  s_waitcnt lgkmcnt(0)
  s_barrier
  s_cmp_lg_u32 s3, 0
  s_cbranch_scc1 L_rspin
  s_waitcnt vmcnt(0)
  v_readlane_b32 s75, v62, s65
  s_nop 1
  s_add_u32 s75, s75, s72
  v_mov_b32 v62, s75
  ds_write_b32 v59, v62 offset:22600
  s_branch L_rgot
L_rspin:
  ds_read_b32 v10, v59 offset:22600
  s_waitcnt lgkmcnt(0)
  v_readfirstlane_b32 s75, v10
  s_nop 1
  s_cmp_eq_u32 s75, -1
  s_cbranch_scc1 L_rspin
L_rgot:
  s_and_b32 s74, s75, 0xffff
  s_cmp_le_u32 s74, 56
  s_cbranch_scc1 L_send
  s_and_b32 s7, s74, 7
  s_lshl_b32 s7, s7, 8
  s_add_u32 s76, s68, s7
  s_bfe_u32 s7, s74, 0x20001
  s_lshl_b32 s7, s7, 8
  s_add_u32 s67, s67, s7
  s_and_b32 s7, s74, 1
  s_lshl_b32 s7, s7, 3
  s_add_u32 s67, s67, s7
  s_add_u32 s77, s76, 32768
  s_add_u32 s78, s76, 65536
  s_add_u32 s79, s76, 98304
  s_lshl_b32 s7, s67, 1
  buffer_load_dwordx2 v[22:23], v56, s[32:35], s67 offen
  s_mov_b32 s68, 0x100000
  s_branch L_hchk
L_hs:
  s_sleep 4
L_hs1:
  s_mov_b64 exec, 1
  buffer_load_dword v62, v31, s[28:31], 0 offen sc1
  s_mov_b64 exec, -1
  s_waitcnt vmcnt(0)
  v_readfirstlane_b32 s75, v62
  s_sub_u32 s68, s68, 1
  s_cmp_eq_u32 s68, 0
  s_cbranch_scc1 L_hok
  s_and_b32 s74, s75, 0xffff
L_hchk:
  s_cmp_lt_u32 s74, 64
  s_cbranch_scc1 L_hs
  s_cmp_lt_u32 s75, 1835008
  s_cbranch_scc1 L_hs
L_hok:
  buffer_load_dwordx4 v[16:19], v26, s[20:23], s7 offen sc1
  buffer_load_dwordx4 v[64:67], v30, s[20:23], s7 offen sc1
  buffer_load_dwordx2 v[128:129], v25, s[60:63], s73 offen offset:0 sc1
  buffer_load_dwordx2 v[130:131], v25, s[60:63], s73 offen offset:128 sc1
  buffer_load_dwordx2 v[132:133], v25, s[60:63], s73 offen offset:256 sc1
  buffer_load_dwordx2 v[134:135], v25, s[60:63], s73 offen offset:384 sc1
  s_waitcnt vmcnt(0)
  v_add_f32 v16, v16, v64
  v_add_f32 v17, v17, v65
  v_add_f32 v18, v18, v66
  v_add_f32 v19, v19, v67
  v_lshlrev_b32 v20, 16, v22
  v_and_b32 v21, 0xffff0000, v22
  v_lshlrev_b32 v22, 16, v23
  v_and_b32 v23, 0xffff0000, v23
  buffer_load_dwordx4 v[144:147], v24, s[60:63], s76 offen sc1
  buffer_load_dwordx4 v[148:151], v24, s[60:63], s77 offen sc1
  buffer_load_dwordx4 v[152:155], v24, s[60:63], s78 offen sc1
  buffer_load_dwordx4 v[156:159], v24, s[60:63], s79 offen sc1
  v_max_f32_dpp v88, v128, v128 quad_perm:[1,0,3,2] row_mask:0xf bank_mask:0xf
  v_max_f32_dpp v89, v130, v130 quad_perm:[1,0,3,2] row_mask:0xf bank_mask:0xf
  v_max_f32_dpp v90, v132, v132 quad_perm:[1,0,3,2] row_mask:0xf bank_mask:0xf
  v_max_f32_dpp v91, v134, v134 quad_perm:[1,0,3,2] row_mask:0xf bank_mask:0xf
  v_sub_f32 v128, v128, v88
  v_sub_f32 v130, v130, v89
  v_sub_f32 v132, v132, v90
  v_sub_f32 v134, v134, v91
  v_mul_f32 v128, s70, v128
  v_mul_f32 v130, s70, v130
  v_mul_f32 v132, s70, v132
  v_mul_f32 v134, s70, v134
  v_exp_f32 v128, v128
  v_exp_f32 v130, v130
  v_exp_f32 v132, v132
  v_exp_f32 v134, v134
  v_mul_f32 v128, v128, v129
  v_mul_f32 v130, v130, v131
  v_mul_f32 v132, v132, v133
  v_mul_f32 v134, v134, v135
  v_add_f32_dpp v88, v128, v128 quad_perm:[1,0,3,2] row_mask:0xf bank_mask:0xf
  v_add_f32_dpp v89, v130, v130 quad_perm:[1,0,3,2] row_mask:0xf bank_mask:0xf
  v_add_f32_dpp v90, v132, v132 quad_perm:[1,0,3,2] row_mask:0xf bank_mask:0xf
  v_add_f32_dpp v91, v134, v134 quad_perm:[1,0,3,2] row_mask:0xf bank_mask:0xf
  v_rcp_f32 v88, v88
  v_rcp_f32 v89, v89
  v_rcp_f32 v90, v90
  v_rcp_f32 v91, v91
  v_mul_f32 v88, v128, v88
  v_mul_f32 v89, v130, v89
  v_mul_f32 v90, v132, v90
  v_mul_f32 v91, v134, v91
  v_add_f32_dpp v16, v16, v16 row_ror:4 row_mask:0xf bank_mask:0xf
  v_add_f32_dpp v17, v17, v17 row_ror:4 row_mask:0xf bank_mask:0xf
  v_add_f32_dpp v18, v18, v18 row_ror:4 row_mask:0xf bank_mask:0xf
  v_add_f32_dpp v19, v19, v19 row_ror:4 row_mask:0xf bank_mask:0xf
  v_add_f32_dpp v16, v16, v16 row_ror:8 row_mask:0xf bank_mask:0xf
  v_add_f32_dpp v17, v17, v17 row_ror:8 row_mask:0xf bank_mask:0xf
  v_add_f32_dpp v18, v18, v18 row_ror:8 row_mask:0xf bank_mask:0xf
  v_add_f32_dpp v19, v19, v19 row_ror:8 row_mask:0xf bank_mask:0xf
  v_mov_b32 v64, v16
  v_mov_b32 v65, v17
  v_mov_b32 v66, v18
  v_mov_b32 v67, v19
  v_permlane16_swap_b32 v64, v16
  v_permlane16_swap_b32 v65, v17
  v_permlane16_swap_b32 v66, v18
  v_permlane16_swap_b32 v67, v19
  v_add_f32 v16, v64, v16
  v_add_f32 v17, v65, v17
  v_add_f32 v18, v66, v18
  v_add_f32 v19, v67, v19
  v_mov_b32 v64, v16
  v_mov_b32 v65, v17
  v_mov_b32 v66, v18
  v_mov_b32 v67, v19
  v_permlane32_swap_b32 v64, v16
  v_permlane32_swap_b32 v65, v17
  v_permlane32_swap_b32 v66, v18
  v_permlane32_swap_b32 v67, v19
  v_add_f32 v16, v64, v16
  v_add_f32 v17, v65, v17
  v_add_f32 v18, v66, v18
  v_add_f32 v19, v67, v19
  v_cvt_pk_bf16_f32 v16, 0, v16
  v_cvt_pk_bf16_f32 v17, 0, v17
  v_cvt_pk_bf16_f32 v18, 0, v18
  v_cvt_pk_bf16_f32 v19, 0, v19
  v_mul_f32 v64, s70, v16
  v_mul_f32 v65, s70, v17
  v_mul_f32 v66, s70, v18
  v_mul_f32 v67, s70, v19
  v_exp_f32 v64, -v64
  v_exp_f32 v65, -v65
  v_exp_f32 v66, -v66
  v_exp_f32 v67, -v67
  v_add_f32 v64, 1.0, v64
  v_add_f32 v65, 1.0, v65
  v_add_f32 v66, 1.0, v66
  v_add_f32 v67, 1.0, v67
  v_rcp_f32 v64, v64
  v_rcp_f32 v65, v65
  v_rcp_f32 v66, v66
  v_rcp_f32 v67, v67
  v_mul_f32 v16, v16, v64
  v_mul_f32 v17, v17, v65
  v_mul_f32 v18, v18, v66
  v_mul_f32 v19, v19, v67
  v_cvt_pk_bf16_f32 v16, 0, v16
  v_cvt_pk_bf16_f32 v17, 0, v17
  v_cvt_pk_bf16_f32 v18, 0, v18
  v_cvt_pk_bf16_f32 v19, 0, v19
  s_branch L_pchk
L_poll:
  buffer_load_dwordx4 v[144:147], v24, s[60:63], s76 offen sc1
  buffer_load_dwordx4 v[148:151], v24, s[60:63], s77 offen sc1
  buffer_load_dwordx4 v[152:155], v24, s[60:63], s78 offen sc1
  buffer_load_dwordx4 v[156:159], v24, s[60:63], s79 offen sc1
L_pchk:
  s_waitcnt vmcnt(2)
  v_max3_u32 v84, v144, v145, v146
  v_max3_u32 v85, v147, v148, v149
  v_max3_u32 v84, v84, v150, v151
  s_waitcnt vmcnt(0)
  v_max3_u32 v85, v85, v152, v153
  v_max3_u32 v84, v84, v154, v155
  v_max3_u32 v85, v85, v156, v157
  v_max3_u32 v84, v84, v158, v159
  v_max_u32 v84, v84, v85
  v_cmp_eq_u32 vcc, -1, v84
  s_nop 1
  s_and_b64 exec, exec, vcc
  s_cbranch_execz L_done
  s_sleep 2
  s_sub_u32 s68, s68, 1
  s_cmp_gt_i32 s68, 0
  s_cbranch_scc1 L_poll
L_done:
  s_mov_b64 exec, -1
L_fin:
  s_nop 0
  v_mul_f32_dpp v72, v88, v144 quad_perm:[0,0,0,0] row_mask:0xf bank_mask:0xf
  v_mul_f32_dpp v73, v88, v145 quad_perm:[0,0,0,0] row_mask:0xf bank_mask:0xf
  v_mul_f32_dpp v74, v88, v146 quad_perm:[0,0,0,0] row_mask:0xf bank_mask:0xf
  v_mul_f32_dpp v75, v88, v147 quad_perm:[0,0,0,0] row_mask:0xf bank_mask:0xf
  v_fmac_f32_dpp v72, v89, v148 quad_perm:[0,0,0,0] row_mask:0xf bank_mask:0xf
  v_fmac_f32_dpp v73, v89, v149 quad_perm:[0,0,0,0] row_mask:0xf bank_mask:0xf
  v_fmac_f32_dpp v74, v89, v150 quad_perm:[0,0,0,0] row_mask:0xf bank_mask:0xf
  v_fmac_f32_dpp v75, v89, v151 quad_perm:[0,0,0,0] row_mask:0xf bank_mask:0xf
  v_fmac_f32_dpp v72, v90, v152 quad_perm:[0,0,0,0] row_mask:0xf bank_mask:0xf
  v_fmac_f32_dpp v73, v90, v153 quad_perm:[0,0,0,0] row_mask:0xf bank_mask:0xf
  v_fmac_f32_dpp v74, v90, v154 quad_perm:[0,0,0,0] row_mask:0xf bank_mask:0xf
  v_fmac_f32_dpp v75, v90, v155 quad_perm:[0,0,0,0] row_mask:0xf bank_mask:0xf
  v_fmac_f32_dpp v72, v91, v156 quad_perm:[0,0,0,0] row_mask:0xf bank_mask:0xf
  v_fmac_f32_dpp v73, v91, v157 quad_perm:[0,0,0,0] row_mask:0xf bank_mask:0xf
  v_fmac_f32_dpp v74, v91, v158 quad_perm:[0,0,0,0] row_mask:0xf bank_mask:0xf
  v_fmac_f32_dpp v75, v91, v159 quad_perm:[0,0,0,0] row_mask:0xf bank_mask:0xf
  v_add_f32_dpp v72, v72, v72 row_ror:4 row_mask:0xf bank_mask:0xf
  v_add_f32_dpp v73, v73, v73 row_ror:4 row_mask:0xf bank_mask:0xf
  v_add_f32_dpp v74, v74, v74 row_ror:4 row_mask:0xf bank_mask:0xf
  v_add_f32_dpp v75, v75, v75 row_ror:4 row_mask:0xf bank_mask:0xf
  v_add_f32_dpp v72, v72, v72 row_ror:8 row_mask:0xf bank_mask:0xf
  v_add_f32_dpp v73, v73, v73 row_ror:8 row_mask:0xf bank_mask:0xf
  v_add_f32_dpp v74, v74, v74 row_ror:8 row_mask:0xf bank_mask:0xf
  v_add_f32_dpp v75, v75, v75 row_ror:8 row_mask:0xf bank_mask:0xf
  v_mov_b32 v76, v72
  v_mov_b32 v77, v73
  v_mov_b32 v78, v74
  v_mov_b32 v79, v75
  v_permlane16_swap_b32 v76, v72
  v_permlane16_swap_b32 v77, v73
  v_permlane16_swap_b32 v78, v74
  v_permlane16_swap_b32 v79, v75
  v_add_f32 v72, v76, v72
  v_add_f32 v73, v77, v73
  v_add_f32 v74, v78, v74
  v_add_f32 v75, v79, v75
  v_mov_b32 v76, v72
  v_mov_b32 v77, v73
  v_mov_b32 v78, v74
  v_mov_b32 v79, v75
  v_permlane32_swap_b32 v76, v72
  v_permlane32_swap_b32 v77, v73
  v_permlane32_swap_b32 v78, v74
  v_permlane32_swap_b32 v79, v75
  v_add_f32 v72, v76, v72
  v_add_f32 v73, v77, v73
  v_add_f32 v74, v78, v74
  v_add_f32 v75, v79, v75
  v_cvt_pk_bf16_f32 v72, 0, v72
  v_cvt_pk_bf16_f32 v73, 0, v73
  v_cvt_pk_bf16_f32 v74, 0, v74
  v_cvt_pk_bf16_f32 v75, 0, v75
  v_mul_f32 v72, v72, v16
  v_mul_f32 v73, v73, v17
  v_mul_f32 v74, v74, v18
  v_mul_f32 v75, v75, v19
  v_cvt_pk_bf16_f32 v72, 0, v72
  v_cvt_pk_bf16_f32 v73, 0, v73
  v_cvt_pk_bf16_f32 v74, 0, v74
  v_cvt_pk_bf16_f32 v75, 0, v75
  v_add_f32 v72, v72, v20
  v_add_f32 v73, v73, v21
  v_add_f32 v74, v74, v22
  v_add_f32 v75, v75, v23
  v_cvt_pk_bf16_f32 v72, v72, v73
  v_cvt_pk_bf16_f32 v73, v74, v75
  s_mov_b64 exec, 15
  buffer_store_dwordx2 v[72:73], v56, s[24:27], s67 offen
  s_mov_b64 exec, -1
L_send:
  s_endpgm
L_helper:
  s_and_b32 s74, s3, 3
  v_and_b32 v11, 15, v1
  v_lshrrev_b32 v12, 4, v1
  v_lshlrev_b32 v56, 10, v12
  v_lshl_add_u32 v56, v11, 4, v56
  v_cmp_eq_u32 vcc, s65, v12
  s_cmp_lt_u32 s2, 28
  s_nop 0
  s_cselect_b64 s[4:5], -1, vcc
  v_mov_b32 v58, 0x10000
  v_cndmask_b32 v58, v58, v56, s[4:5]
  v_lshlrev_b32 v57, 18, v12
  v_lshl_add_u32 v57, v11, 4, v57
  s_lshl_b32 s4, s74, 20
  s_lshl_b32 s5, s64, 8
  s_add_u32 s75, s4, s5
  s_lshl_b32 s6, s69, 15
  s_waitcnt lgkmcnt(0)
  s_mov_b32 s12, s36
  s_mov_b32 s13, s37
  s_mov_b32 s14, 4096
  s_mov_b32 s15, 0x00020000
  s_mov_b32 s60, s58
  s_mov_b32 s61, s59
  s_mov_b32 s62, 4194304
  s_mov_b32 s63, 0x00020000
  s_mul_i32 s5, s66, 2048
  s_cmp_lg_u32 s74, 0
  s_cbranch_scc1 L_nopoison
  v_lshlrev_b32 v20, 4, v1
  v_mov_b32 v16, -1
  v_mov_b32 v17, -1
  v_mov_b32 v18, -1
  v_mov_b32 v19, -1
  buffer_store_dwordx4 v[16:19], v20, s[60:63], s5 offen sc1
  buffer_store_dwordx4 v[16:19], v20, s[60:63], s5 offen offset:1024 sc1
L_nopoison:
  buffer_load_dwordx4 v[64:67], v58, s[12:15], 0 offen offset:0
  buffer_load_dwordx4 v[68:71], v58, s[12:15], 0 offen offset:256
  buffer_load_dwordx4 v[72:75], v58, s[12:15], 0 offen offset:512
  buffer_load_dwordx4 v[76:79], v58, s[12:15], 0 offen offset:768
  s_mov_b32 s16, s42
  s_mov_b32 s17, s43
  s_mov_b32 s18, 4194304
  s_mov_b32 s19, 0x00020000
  v_lshrrev_b32 v59, 1, v1
  v_lshlrev_b32 v59, 13, v59
  v_and_b32 v63, 1, v1
  v_lshl_add_u32 v59, v63, 7, v59
  s_lshl_b32 s4, s69, 19
  s_lshl_b32 s5, s74, 17
  s_add_u32 s4, s4, s5
  s_lshl_b32 s5, s64, 8
  s_add_u32 s4, s4, s5
  s_mov_b32 exec_hi, 0
  buffer_load_dword v63, v59, s[16:19], s4 offen
  s_mov_b32 exec_hi, -1
  s_add_u32 s4, s75, s6
  buffer_load_dwordx4 v[128:131], v57, s[16:19], s4 offen
  s_add_u32 s6, s6, 8192
  s_and_b32 s6, s6, 262143
  s_add_u32 s4, s75, s6
  buffer_load_dwordx4 v[132:135], v57, s[16:19], s4 offen
  s_add_u32 s6, s6, 8192
  s_and_b32 s6, s6, 262143
  s_add_u32 s4, s75, s6
  buffer_load_dwordx4 v[136:139], v57, s[16:19], s4 offen
  s_add_u32 s6, s6, 8192
  s_and_b32 s6, s6, 262143
  v_and_b32 v13, 1, v1
  v_lshlrev_b32 v13, 4, v13
  v_mov_b32 v14, 0xffff
  v_lshlrev_b32 v14, v13, v14
  v_bfe_u32 v13, v1, 1, 2
  v_cmp_eq_u32 vcc, 0, v13
  s_nop 1
  v_cndmask_b32 v4, 0, v14, vcc
  v_cmp_eq_u32 vcc, 1, v13
  s_nop 1
  v_cndmask_b32 v5, 0, v14, vcc
  v_cmp_eq_u32 vcc, 2, v13
  s_nop 1
  v_cndmask_b32 v6, 0, v14, vcc
  v_cmp_eq_u32 vcc, 3, v13
  s_nop 1
  v_cndmask_b32 v7, 0, v14, vcc
  v_and_b32 v11, 15, v1
  v_lshrrev_b32 v12, 4, v1
  v_and_b32 v13, 1, v12
  v_lshlrev_b32 v13, 4, v13
  v_lshl_add_u32 v60, v11, 5, v13
  s_mov_b32 s70, 0x3fb8aa3b
  s_mov_b32 s71, 0x3db504f3
  s_mov_b32 s20, s44
  s_mov_b32 s21, s45
  s_mov_b32 s22, 4194304
  s_mov_b32 s23, 0x00020000
  s_mov_b32 s32, s52
  s_mov_b32 s33, s53
  s_mov_b32 s34, 1835008
  s_mov_b32 s35, 0x00020000
  s_add_u32 s8, s58, 1048576
  s_addc_u32 s9, s59, 0
  s_mov_b32 s10, 229376
  s_mov_b32 s11, 0x00020000
  s_mov_b32 s72, 0x01000100
  s_mov_b32 s73, 0x03020302
  s_waitcnt vmcnt(4)
  v_lshlrev_b32 v80, 16, v64
  v_and_b32 v81, 0xffff0000, v64
  v_lshlrev_b32 v82, 16, v65
  v_and_b32 v83, 0xffff0000, v65
  v_lshlrev_b32 v84, 16, v66
  v_and_b32 v85, 0xffff0000, v66
  v_lshlrev_b32 v86, 16, v67
  v_and_b32 v87, 0xffff0000, v67
  v_lshlrev_b32 v88, 16, v68
  v_and_b32 v89, 0xffff0000, v68
  v_lshlrev_b32 v90, 16, v69
  v_and_b32 v91, 0xffff0000, v69
  v_lshlrev_b32 v92, 16, v70
  v_and_b32 v93, 0xffff0000, v70
  v_lshlrev_b32 v94, 16, v71
  v_and_b32 v95, 0xffff0000, v71
  v_lshlrev_b32 v96, 16, v72
  v_and_b32 v97, 0xffff0000, v72
  v_lshlrev_b32 v98, 16, v73
  v_and_b32 v99, 0xffff0000, v73
  v_lshlrev_b32 v100, 16, v74
  v_and_b32 v101, 0xffff0000, v74
  v_lshlrev_b32 v102, 16, v75
  v_and_b32 v103, 0xffff0000, v75
  v_lshlrev_b32 v104, 16, v76
  v_and_b32 v105, 0xffff0000, v76
  v_lshlrev_b32 v106, 16, v77
  v_and_b32 v107, 0xffff0000, v77
  v_lshlrev_b32 v108, 16, v78
  v_and_b32 v109, 0xffff0000, v78
  v_lshlrev_b32 v110, 16, v79
  v_and_b32 v111, 0xffff0000, v79
  v_add_f32 v112, v80, v84
  v_add_f32 v113, v81, v85
  v_add_f32 v114, v82, v86
  v_add_f32 v115, v83, v87
  v_add_f32 v112, v112, v88
  v_add_f32 v113, v113, v89
  v_add_f32 v114, v114, v90
  v_add_f32 v115, v115, v91
  v_add_f32 v112, v112, v92
  v_add_f32 v113, v113, v93
  v_add_f32 v114, v114, v94
  v_add_f32 v115, v115, v95
  v_add_f32 v112, v112, v96
  v_add_f32 v113, v113, v97
  v_add_f32 v114, v114, v98
  v_add_f32 v115, v115, v99
  v_add_f32 v112, v112, v100
  v_add_f32 v113, v113, v101
  v_add_f32 v114, v114, v102
  v_add_f32 v115, v115, v103
  v_add_f32 v112, v112, v104
  v_add_f32 v113, v113, v105
  v_add_f32 v114, v114, v106
  v_add_f32 v115, v115, v107
  v_add_f32 v112, v112, v108
  v_add_f32 v113, v113, v109
  v_add_f32 v114, v114, v110
  v_add_f32 v115, v115, v111
  v_add_f32 v112, v112, v113
  v_add_f32 v114, v114, v115
  v_add_f32 v112, v112, v114
  s_nop 1
  v_add_f32_dpp v112, v112, v112 row_ror:8 row_mask:0xf bank_mask:0xf
  s_nop 1
  v_add_f32_dpp v112, v112, v112 row_ror:4 row_mask:0xf bank_mask:0xf
  s_nop 1
  v_add_f32_dpp v112, v112, v112 row_ror:2 row_mask:0xf bank_mask:0xf
  s_nop 1
  v_add_f32_dpp v112, v112, v112 row_ror:1 row_mask:0xf bank_mask:0xf
  v_mul_f32 v112, 0x3b000000, v112
  v_sub_f32 v116, v80, v112
  v_sub_f32 v117, v81, v112
  s_waitcnt vmcnt(2)
  s_add_u32 s4, s75, s6
  buffer_load_dwordx4 v[140:143], v57, s[16:19], s4 offen
  s_add_u32 s6, s6, 8192
  s_and_b32 s6, s6, 262143
  v_sub_f32 v118, v82, v112
  v_sub_f32 v119, v83, v112
  v_mul_f32 v120, v116, v116
  v_mul_f32 v121, v117, v117
  v_mul_f32 v122, v118, v118
  v_mul_f32 v123, v119, v119
  v_sub_f32 v116, v84, v112
  v_sub_f32 v117, v85, v112
  v_sub_f32 v118, v86, v112
  v_sub_f32 v119, v87, v112
  v_fmac_f32 v120, v116, v116
  v_fmac_f32 v121, v117, v117
  v_fmac_f32 v122, v118, v118
  v_fmac_f32 v123, v119, v119
  v_sub_f32 v116, v88, v112
  v_sub_f32 v117, v89, v112
  v_sub_f32 v118, v90, v112
  v_sub_f32 v119, v91, v112
  v_fmac_f32 v120, v116, v116
  v_fmac_f32 v121, v117, v117
  v_fmac_f32 v122, v118, v118
  v_fmac_f32 v123, v119, v119
  v_sub_f32 v116, v92, v112
  v_sub_f32 v117, v93, v112
  v_sub_f32 v118, v94, v112
  v_sub_f32 v119, v95, v112
  v_fmac_f32 v120, v116, v116
  v_fmac_f32 v121, v117, v117
  v_fmac_f32 v122, v118, v118
  v_fmac_f32 v123, v119, v119
  v_sub_f32 v116, v96, v112
  v_sub_f32 v117, v97, v112
  v_sub_f32 v118, v98, v112
  v_sub_f32 v119, v99, v112
  v_fmac_f32 v120, v116, v116
  v_fmac_f32 v121, v117, v117
  v_fmac_f32 v122, v118, v118
  v_fmac_f32 v123, v119, v119
  v_sub_f32 v116, v100, v112
  v_sub_f32 v117, v101, v112
  v_sub_f32 v118, v102, v112
  v_sub_f32 v119, v103, v112
  v_fmac_f32 v120, v116, v116
  v_fmac_f32 v121, v117, v117
  v_fmac_f32 v122, v118, v118
  v_fmac_f32 v123, v119, v119
  v_sub_f32 v116, v104, v112
  v_sub_f32 v117, v105, v112
  v_sub_f32 v118, v106, v112
  v_sub_f32 v119, v107, v112
  v_fmac_f32 v120, v116, v116
  v_fmac_f32 v121, v117, v117
  v_fmac_f32 v122, v118, v118
  v_fmac_f32 v123, v119, v119
  v_sub_f32 v116, v108, v112
  v_sub_f32 v117, v109, v112
  v_sub_f32 v118, v110, v112
  v_sub_f32 v119, v111, v112
  v_fmac_f32 v120, v116, v116
  v_fmac_f32 v121, v117, v117
  v_fmac_f32 v122, v118, v118
  v_fmac_f32 v123, v119, v119
  v_add_f32 v120, v120, v121
  v_add_f32 v122, v122, v123
  v_add_f32 v120, v120, v122
  s_nop 1
  v_add_f32_dpp v120, v120, v120 row_ror:8 row_mask:0xf bank_mask:0xf
  s_nop 1
  v_add_f32_dpp v120, v120, v120 row_ror:4 row_mask:0xf bank_mask:0xf
  s_nop 1
  v_add_f32_dpp v120, v120, v120 row_ror:2 row_mask:0xf bank_mask:0xf
  s_nop 1
  v_add_f32_dpp v120, v120, v120 row_ror:1 row_mask:0xf bank_mask:0xf
  v_mul_f32 v120, 0x3b000000, v120
  s_waitcnt vmcnt(2)
  s_add_u32 s4, s75, s6
  buffer_load_dwordx4 v[144:147], v57, s[16:19], s4 offen
  s_add_u32 s6, s6, 8192
  s_and_b32 s6, s6, 262143
  v_cvt_pk_bf16_f32 v112, 0, v112
  v_cvt_pk_bf16_f32 v120, 0, v120
  v_add_f32 v120, 0x3727c5ac, v120
  v_cvt_pk_bf16_f32 v120, 0, v120
  v_sqrt_f32 v120, v120
  s_nop 0
  v_cvt_pk_bf16_f32 v120, 0, v120
  v_rcp_f32 v121, v120
  v_sub_f32 v80, v80, v112
  v_sub_f32 v81, v81, v112
  v_sub_f32 v82, v82, v112
  v_sub_f32 v83, v83, v112
  v_cvt_pk_bf16_f32 v80, 0, v80
  v_cvt_pk_bf16_f32 v81, 0, v81
  v_cvt_pk_bf16_f32 v82, 0, v82
  v_cvt_pk_bf16_f32 v83, 0, v83
  v_mul_f32 v116, v80, v121
  v_mul_f32 v117, v81, v121
  v_mul_f32 v118, v82, v121
  v_mul_f32 v119, v83, v121
  v_fma_f32 v80, -v116, v120, v80
  v_fma_f32 v81, -v117, v120, v81
  v_fma_f32 v82, -v118, v120, v82
  v_fma_f32 v83, -v119, v120, v83
  v_fmac_f32 v116, v80, v121
  v_fmac_f32 v117, v81, v121
  v_fmac_f32 v118, v82, v121
  v_fmac_f32 v119, v83, v121
  v_cvt_pk_bf16_f32 v64, v116, v117
  v_cvt_pk_bf16_f32 v65, v118, v119
  v_sub_f32 v84, v84, v112
  v_sub_f32 v85, v85, v112
  v_sub_f32 v86, v86, v112
  v_sub_f32 v87, v87, v112
  v_cvt_pk_bf16_f32 v84, 0, v84
  v_cvt_pk_bf16_f32 v85, 0, v85
  v_cvt_pk_bf16_f32 v86, 0, v86
  v_cvt_pk_bf16_f32 v87, 0, v87
  v_mul_f32 v116, v84, v121
  v_mul_f32 v117, v85, v121
  v_mul_f32 v118, v86, v121
  v_mul_f32 v119, v87, v121
  v_fma_f32 v84, -v116, v120, v84
  v_fma_f32 v85, -v117, v120, v85
  v_fma_f32 v86, -v118, v120, v86
  v_fma_f32 v87, -v119, v120, v87
  v_fmac_f32 v116, v84, v121
  v_fmac_f32 v117, v85, v121
  v_fmac_f32 v118, v86, v121
  v_fmac_f32 v119, v87, v121
  v_cvt_pk_bf16_f32 v66, v116, v117
  v_cvt_pk_bf16_f32 v67, v118, v119
  v_sub_f32 v88, v88, v112
  v_sub_f32 v89, v89, v112
  v_sub_f32 v90, v90, v112
  v_sub_f32 v91, v91, v112
  v_cvt_pk_bf16_f32 v88, 0, v88
  v_cvt_pk_bf16_f32 v89, 0, v89
  v_cvt_pk_bf16_f32 v90, 0, v90
  v_cvt_pk_bf16_f32 v91, 0, v91
  v_mul_f32 v116, v88, v121
  v_mul_f32 v117, v89, v121
  v_mul_f32 v118, v90, v121
  v_mul_f32 v119, v91, v121
  v_fma_f32 v88, -v116, v120, v88
  v_fma_f32 v89, -v117, v120, v89
  v_fma_f32 v90, -v118, v120, v90
  v_fma_f32 v91, -v119, v120, v91
  v_fmac_f32 v116, v88, v121
  v_fmac_f32 v117, v89, v121
  v_fmac_f32 v118, v90, v121
  s_waitcnt vmcnt(2)
  s_add_u32 s4, s75, s6
  buffer_load_dwordx4 v[148:151], v57, s[16:19], s4 offen
  s_add_u32 s6, s6, 8192
  s_and_b32 s6, s6, 262143
  v_fmac_f32 v119, v91, v121
  v_cvt_pk_bf16_f32 v68, v116, v117
  v_cvt_pk_bf16_f32 v69, v118, v119
  v_sub_f32 v92, v92, v112
  v_sub_f32 v93, v93, v112
  v_sub_f32 v94, v94, v112
  v_sub_f32 v95, v95, v112
  v_cvt_pk_bf16_f32 v92, 0, v92
  v_cvt_pk_bf16_f32 v93, 0, v93
  v_cvt_pk_bf16_f32 v94, 0, v94
  v_cvt_pk_bf16_f32 v95, 0, v95
  v_mul_f32 v116, v92, v121
  v_mul_f32 v117, v93, v121
  v_mul_f32 v118, v94, v121
  v_mul_f32 v119, v95, v121
  v_fma_f32 v92, -v116, v120, v92
  v_fma_f32 v93, -v117, v120, v93
  v_fma_f32 v94, -v118, v120, v94
  v_fma_f32 v95, -v119, v120, v95
  v_fmac_f32 v116, v92, v121
  v_fmac_f32 v117, v93, v121
  v_fmac_f32 v118, v94, v121
  v_fmac_f32 v119, v95, v121
  v_cvt_pk_bf16_f32 v70, v116, v117
  v_cvt_pk_bf16_f32 v71, v118, v119
  v_sub_f32 v96, v96, v112
  v_sub_f32 v97, v97, v112
  v_sub_f32 v98, v98, v112
  v_sub_f32 v99, v99, v112
  v_cvt_pk_bf16_f32 v96, 0, v96
  v_cvt_pk_bf16_f32 v97, 0, v97
  v_cvt_pk_bf16_f32 v98, 0, v98
  v_cvt_pk_bf16_f32 v99, 0, v99
  v_mul_f32 v116, v96, v121
  v_mul_f32 v117, v97, v121
  v_mul_f32 v118, v98, v121
  v_mul_f32 v119, v99, v121
  v_fma_f32 v96, -v116, v120, v96
  v_fma_f32 v97, -v117, v120, v97
  v_fma_f32 v98, -v118, v120, v98
  v_fma_f32 v99, -v119, v120, v99
  v_fmac_f32 v116, v96, v121
  v_fmac_f32 v117, v97, v121
  v_fmac_f32 v118, v98, v121
  v_fmac_f32 v119, v99, v121
  v_cvt_pk_bf16_f32 v72, v116, v117
  v_cvt_pk_bf16_f32 v73, v118, v119
  v_sub_f32 v100, v100, v112
  v_sub_f32 v101, v101, v112
  v_sub_f32 v102, v102, v112
  v_sub_f32 v103, v103, v112
  v_cvt_pk_bf16_f32 v100, 0, v100
  v_cvt_pk_bf16_f32 v101, 0, v101
  v_cvt_pk_bf16_f32 v102, 0, v102
  v_cvt_pk_bf16_f32 v103, 0, v103
  v_mul_f32 v116, v100, v121
  v_mul_f32 v117, v101, v121
  v_mul_f32 v118, v102, v121
  v_mul_f32 v119, v103, v121
  v_fma_f32 v100, -v116, v120, v100
  v_fma_f32 v101, -v117, v120, v101
  v_fma_f32 v102, -v118, v120, v102
  v_fma_f32 v103, -v119, v120, v103
  v_fmac_f32 v116, v100, v121
  v_fmac_f32 v117, v101, v121
  v_fmac_f32 v118, v102, v121
  v_fmac_f32 v119, v103, v121
  v_cvt_pk_bf16_f32 v74, v116, v117
  v_cvt_pk_bf16_f32 v75, v118, v119
  v_sub_f32 v104, v104, v112
  s_waitcnt vmcnt(2)
  s_add_u32 s4, s75, s6
  buffer_load_dwordx4 v[152:155], v57, s[16:19], s4 offen
  s_add_u32 s6, s6, 8192
  s_and_b32 s6, s6, 262143
  v_sub_f32 v105, v105, v112
  v_sub_f32 v106, v106, v112
  v_sub_f32 v107, v107, v112
  v_cvt_pk_bf16_f32 v104, 0, v104
  v_cvt_pk_bf16_f32 v105, 0, v105
  v_cvt_pk_bf16_f32 v106, 0, v106
  v_cvt_pk_bf16_f32 v107, 0, v107
  v_mul_f32 v116, v104, v121
  v_mul_f32 v117, v105, v121
  v_mul_f32 v118, v106, v121
  v_mul_f32 v119, v107, v121
  v_fma_f32 v104, -v116, v120, v104
  v_fma_f32 v105, -v117, v120, v105
  v_fma_f32 v106, -v118, v120, v106
  v_fma_f32 v107, -v119, v120, v107
  v_fmac_f32 v116, v104, v121
  v_fmac_f32 v117, v105, v121
  v_fmac_f32 v118, v106, v121
  v_fmac_f32 v119, v107, v121
  v_cvt_pk_bf16_f32 v76, v116, v117
  v_cvt_pk_bf16_f32 v77, v118, v119
  v_sub_f32 v108, v108, v112
  v_sub_f32 v109, v109, v112
  v_sub_f32 v110, v110, v112
  v_sub_f32 v111, v111, v112
  v_cvt_pk_bf16_f32 v108, 0, v108
  v_cvt_pk_bf16_f32 v109, 0, v109
  v_cvt_pk_bf16_f32 v110, 0, v110
  v_cvt_pk_bf16_f32 v111, 0, v111
  v_mul_f32 v116, v108, v121
  v_mul_f32 v117, v109, v121
  v_mul_f32 v118, v110, v121
  v_mul_f32 v119, v111, v121
  v_fma_f32 v108, -v116, v120, v108
  v_fma_f32 v109, -v117, v120, v109
  v_fma_f32 v110, -v118, v120, v110
  v_fma_f32 v111, -v119, v120, v111
  v_fmac_f32 v116, v108, v121
  v_fmac_f32 v117, v109, v121
  v_fmac_f32 v118, v110, v121
  v_fmac_f32 v119, v111, v121
  v_cvt_pk_bf16_f32 v78, v116, v117
  v_cvt_pk_bf16_f32 v79, v118, v119
  s_lshl_b32 s5, s74, 12
  v_add_u32 v58, s5, v56
  ds_write_b128 v58, v[64:67] offset:0
  ds_write_b128 v58, v[68:71] offset:256
  ds_write_b128 v58, v[72:75] offset:512
  ds_write_b128 v58, v[76:79] offset:768
  s_lshl_b32 s4, s65, 10
  s_add_u32 s5, s5, s4
  s_lshl_b32 s4, s74, 8
  s_add_u32 s5, s5, s4
  v_lshlrev_b32 v58, 6, v12
  v_add_u32 v58, s5, v58
  s_lshl_b32 s5, s69, 3
  s_waitcnt lgkmcnt(0)
  v_add_u32 v59, s5, v58
  ds_read_b64 v[80:81], v59 offset:0
  s_add_u32 s5, s5, 8
  s_and_b32 s5, s5, 63
  v_add_u32 v59, s5, v58
  ds_read_b64 v[82:83], v59 offset:0
  s_add_u32 s5, s5, 8
  s_and_b32 s5, s5, 63
  v_add_u32 v59, s5, v58
  ds_read_b64 v[84:85], v59 offset:0
  s_add_u32 s5, s5, 8
  s_and_b32 s5, s5, 63
  v_add_u32 v59, s5, v58
  ds_read_b64 v[86:87], v59 offset:0
  s_add_u32 s5, s5, 8
  s_and_b32 s5, s5, 63
  v_add_u32 v59, s5, v58
  ds_read_b64 v[88:89], v59 offset:0
  s_add_u32 s5, s5, 8
  s_and_b32 s5, s5, 63
  v_add_u32 v59, s5, v58
  ds_read_b64 v[90:91], v59 offset:0
  s_add_u32 s5, s5, 8
  s_and_b32 s5, s5, 63
  v_add_u32 v59, s5, v58
  ds_read_b64 v[92:93], v59 offset:0
  s_add_u32 s5, s5, 8
  s_and_b32 s5, s5, 63
  v_add_u32 v59, s5, v58
  ds_read_b64 v[94:95], v59 offset:0
  s_add_u32 s5, s5, 8
  s_and_b32 s5, s5, 63
  s_waitcnt lgkmcnt(0)
  v_perm_b32 v58, v80, v80, s72
  v_and_b32 v40, v58, v4
  v_and_b32 v41, v58, v5
  v_and_b32 v42, v58, v6
  v_and_b32 v43, v58, v7
  s_waitcnt vmcnt(2)
  s_add_u32 s4, s75, s6
  buffer_load_dwordx4 v[156:159], v57, s[16:19], s4 offen
  s_add_u32 s6, s6, 8192
  s_and_b32 s6, s6, 262143
  v_mfma_f32_16x16x32_bf16 v[96:99], v[40:43], v[128:131], 0
  v_perm_b32 v58, v80, v80, s73
  v_and_b32 v44, v58, v4
  v_and_b32 v45, v58, v5
  v_and_b32 v46, v58, v6
  v_and_b32 v47, v58, v7
  s_waitcnt vmcnt(2)
  s_add_u32 s4, s75, s6
  buffer_load_dwordx4 v[160:163], v57, s[16:19], s4 offen
  s_add_u32 s6, s6, 8192
  s_and_b32 s6, s6, 262143
  v_mfma_f32_16x16x32_bf16 v[96:99], v[44:47], v[132:135], v[96:99]
  v_perm_b32 v58, v81, v81, s72
  v_and_b32 v48, v58, v4
  v_and_b32 v49, v58, v5
  v_and_b32 v50, v58, v6
  v_and_b32 v51, v58, v7
  s_waitcnt vmcnt(2)
  s_add_u32 s4, s75, s6
  buffer_load_dwordx4 v[164:167], v57, s[16:19], s4 offen
  s_add_u32 s6, s6, 8192
  s_and_b32 s6, s6, 262143
  v_mfma_f32_16x16x32_bf16 v[96:99], v[48:51], v[136:139], v[96:99]
  v_perm_b32 v58, v81, v81, s73
  v_and_b32 v52, v58, v4
  v_and_b32 v53, v58, v5
  v_and_b32 v54, v58, v6
  v_and_b32 v55, v58, v7
  s_waitcnt vmcnt(2)
  s_add_u32 s4, s75, s6
  buffer_load_dwordx4 v[168:171], v57, s[16:19], s4 offen
  s_add_u32 s6, s6, 8192
  s_and_b32 s6, s6, 262143
  v_mfma_f32_16x16x32_bf16 v[96:99], v[52:55], v[140:143], v[96:99]
  v_perm_b32 v58, v82, v82, s72
  v_and_b32 v40, v58, v4
  v_and_b32 v41, v58, v5
  v_and_b32 v42, v58, v6
  v_and_b32 v43, v58, v7
  s_waitcnt vmcnt(2)
  s_add_u32 s4, s75, s6
  buffer_load_dwordx4 v[172:175], v57, s[16:19], s4 offen
  s_add_u32 s6, s6, 8192
  s_and_b32 s6, s6, 262143
  v_mfma_f32_16x16x32_bf16 v[96:99], v[40:43], v[144:147], v[96:99]
  v_perm_b32 v58, v82, v82, s73
  v_and_b32 v44, v58, v4
  v_and_b32 v45, v58, v5
  v_and_b32 v46, v58, v6
  v_and_b32 v47, v58, v7
  s_waitcnt vmcnt(2)
  s_add_u32 s4, s75, s6
  buffer_load_dwordx4 v[176:179], v57, s[16:19], s4 offen
  s_add_u32 s6, s6, 8192
  s_and_b32 s6, s6, 262143
  v_mfma_f32_16x16x32_bf16 v[96:99], v[44:47], v[148:151], v[96:99]
  v_perm_b32 v58, v83, v83, s72
  v_and_b32 v48, v58, v4
  v_and_b32 v49, v58, v5
  v_and_b32 v50, v58, v6
  v_and_b32 v51, v58, v7
  s_waitcnt vmcnt(2)
  s_add_u32 s4, s75, s6
  buffer_load_dwordx4 v[180:183], v57, s[16:19], s4 offen
  s_add_u32 s6, s6, 8192
  s_and_b32 s6, s6, 262143
  v_mfma_f32_16x16x32_bf16 v[96:99], v[48:51], v[152:155], v[96:99]
  v_perm_b32 v58, v83, v83, s73
  v_and_b32 v52, v58, v4
  v_and_b32 v53, v58, v5
  v_and_b32 v54, v58, v6
  v_and_b32 v55, v58, v7
  s_waitcnt vmcnt(2)
  s_add_u32 s4, s75, s6
  buffer_load_dwordx4 v[184:187], v57, s[16:19], s4 offen
  s_add_u32 s6, s6, 8192
  s_and_b32 s6, s6, 262143
  v_mfma_f32_16x16x32_bf16 v[96:99], v[52:55], v[156:159], v[96:99]
  v_perm_b32 v58, v84, v84, s72
  v_and_b32 v40, v58, v4
  v_and_b32 v41, v58, v5
  v_and_b32 v42, v58, v6
  v_and_b32 v43, v58, v7
  s_waitcnt vmcnt(2)
  s_add_u32 s4, s75, s6
  buffer_load_dwordx4 v[188:191], v57, s[16:19], s4 offen
  s_add_u32 s6, s6, 8192
  s_and_b32 s6, s6, 262143
  v_mfma_f32_16x16x32_bf16 v[96:99], v[40:43], v[160:163], v[96:99]
  v_perm_b32 v58, v84, v84, s73
  v_and_b32 v44, v58, v4
  v_and_b32 v45, v58, v5
  v_and_b32 v46, v58, v6
  v_and_b32 v47, v58, v7
  s_waitcnt vmcnt(2)
  s_add_u32 s4, s75, s6
  buffer_load_dwordx4 v[192:195], v57, s[16:19], s4 offen
  s_add_u32 s6, s6, 8192
  s_and_b32 s6, s6, 262143
  v_mfma_f32_16x16x32_bf16 v[96:99], v[44:47], v[164:167], v[96:99]
  v_perm_b32 v58, v85, v85, s72
  v_and_b32 v48, v58, v4
  v_and_b32 v49, v58, v5
  v_and_b32 v50, v58, v6
  v_and_b32 v51, v58, v7
  s_waitcnt vmcnt(2)
  s_add_u32 s4, s75, s6
  buffer_load_dwordx4 v[196:199], v57, s[16:19], s4 offen
  s_add_u32 s6, s6, 8192
  s_and_b32 s6, s6, 262143
  v_mfma_f32_16x16x32_bf16 v[96:99], v[48:51], v[168:171], v[96:99]
  v_perm_b32 v58, v85, v85, s73
  v_and_b32 v52, v58, v4
  v_and_b32 v53, v58, v5
  v_and_b32 v54, v58, v6
  v_and_b32 v55, v58, v7
  s_waitcnt vmcnt(2)
  s_add_u32 s4, s75, s6
  buffer_load_dwordx4 v[200:203], v57, s[16:19], s4 offen
  s_add_u32 s6, s6, 8192
  s_and_b32 s6, s6, 262143
  v_mfma_f32_16x16x32_bf16 v[96:99], v[52:55], v[172:175], v[96:99]
  v_perm_b32 v58, v86, v86, s72
  v_and_b32 v40, v58, v4
  v_and_b32 v41, v58, v5
  v_and_b32 v42, v58, v6
  v_and_b32 v43, v58, v7
  s_waitcnt vmcnt(2)
  s_add_u32 s4, s75, s6
  buffer_load_dwordx4 v[204:207], v57, s[16:19], s4 offen
  s_add_u32 s6, s6, 8192
  s_and_b32 s6, s6, 262143
  v_mfma_f32_16x16x32_bf16 v[96:99], v[40:43], v[176:179], v[96:99]
  v_perm_b32 v58, v86, v86, s73
  v_and_b32 v44, v58, v4
  v_and_b32 v45, v58, v5
  v_and_b32 v46, v58, v6
  v_and_b32 v47, v58, v7
  s_waitcnt vmcnt(2)
  s_add_u32 s4, s75, s6
  buffer_load_dwordx4 v[208:211], v57, s[16:19], s4 offen
  s_add_u32 s6, s6, 8192
  s_and_b32 s6, s6, 262143
  v_mfma_f32_16x16x32_bf16 v[96:99], v[44:47], v[180:183], v[96:99]
  v_perm_b32 v58, v87, v87, s72
  v_and_b32 v48, v58, v4
  v_and_b32 v49, v58, v5
  v_and_b32 v50, v58, v6
  v_and_b32 v51, v58, v7
  s_waitcnt vmcnt(2)
  s_add_u32 s4, s75, s6
  buffer_load_dwordx4 v[212:215], v57, s[16:19], s4 offen
  s_add_u32 s6, s6, 8192
  s_and_b32 s6, s6, 262143
  v_mfma_f32_16x16x32_bf16 v[96:99], v[48:51], v[184:187], v[96:99]
  v_perm_b32 v58, v87, v87, s73
  v_and_b32 v52, v58, v4
  v_and_b32 v53, v58, v5
  v_and_b32 v54, v58, v6
  v_and_b32 v55, v58, v7
  s_waitcnt vmcnt(2)
  s_add_u32 s4, s75, s6
  buffer_load_dwordx4 v[216:219], v57, s[16:19], s4 offen
  s_add_u32 s6, s6, 8192
  s_and_b32 s6, s6, 262143
  v_mfma_f32_16x16x32_bf16 v[96:99], v[52:55], v[188:191], v[96:99]
  v_perm_b32 v58, v88, v88, s72
  v_and_b32 v40, v58, v4
  v_and_b32 v41, v58, v5
  v_and_b32 v42, v58, v6
  v_and_b32 v43, v58, v7
  s_waitcnt vmcnt(2)
  s_add_u32 s4, s75, s6
  buffer_load_dwordx4 v[220:223], v57, s[16:19], s4 offen
  s_add_u32 s6, s6, 8192
  s_and_b32 s6, s6, 262143
  v_mfma_f32_16x16x32_bf16 v[96:99], v[40:43], v[192:195], v[96:99]
  v_perm_b32 v58, v88, v88, s73
  v_and_b32 v44, v58, v4
  v_and_b32 v45, v58, v5
  v_and_b32 v46, v58, v6
  v_and_b32 v47, v58, v7
  s_waitcnt vmcnt(2)
  s_add_u32 s4, s75, s6
  buffer_load_dwordx4 v[224:227], v57, s[16:19], s4 offen
  s_add_u32 s6, s6, 8192
  s_and_b32 s6, s6, 262143
  v_mfma_f32_16x16x32_bf16 v[96:99], v[44:47], v[196:199], v[96:99]
  v_perm_b32 v58, v89, v89, s72
  v_and_b32 v48, v58, v4
  v_and_b32 v49, v58, v5
  v_and_b32 v50, v58, v6
  v_and_b32 v51, v58, v7
  s_waitcnt vmcnt(2)
  s_add_u32 s4, s75, s6
  buffer_load_dwordx4 v[228:231], v57, s[16:19], s4 offen
  s_add_u32 s6, s6, 8192
  s_and_b32 s6, s6, 262143
  v_mfma_f32_16x16x32_bf16 v[96:99], v[48:51], v[200:203], v[96:99]
  v_perm_b32 v58, v89, v89, s73
  v_and_b32 v52, v58, v4
  v_and_b32 v53, v58, v5
  v_and_b32 v54, v58, v6
  v_and_b32 v55, v58, v7
  s_waitcnt vmcnt(2)
  s_add_u32 s4, s75, s6
  buffer_load_dwordx4 v[232:235], v57, s[16:19], s4 offen
  s_add_u32 s6, s6, 8192
  s_and_b32 s6, s6, 262143
  v_mfma_f32_16x16x32_bf16 v[96:99], v[52:55], v[204:207], v[96:99]
  v_perm_b32 v58, v90, v90, s72
  v_and_b32 v40, v58, v4
  v_and_b32 v41, v58, v5
  v_and_b32 v42, v58, v6
  v_and_b32 v43, v58, v7
  s_waitcnt vmcnt(2)
  s_add_u32 s4, s75, s6
  buffer_load_dwordx4 v[236:239], v57, s[16:19], s4 offen
  s_add_u32 s6, s6, 8192
  s_and_b32 s6, s6, 262143
  v_mfma_f32_16x16x32_bf16 v[96:99], v[40:43], v[208:211], v[96:99]
  v_perm_b32 v58, v90, v90, s73
  v_and_b32 v44, v58, v4
  v_and_b32 v45, v58, v5
  v_and_b32 v46, v58, v6
  v_and_b32 v47, v58, v7
  s_waitcnt vmcnt(2)
  s_add_u32 s4, s75, s6
  buffer_load_dwordx4 v[240:243], v57, s[16:19], s4 offen
  s_add_u32 s6, s6, 8192
  s_and_b32 s6, s6, 262143
  v_mfma_f32_16x16x32_bf16 v[96:99], v[44:47], v[212:215], v[96:99]
  v_perm_b32 v58, v91, v91, s72
  v_and_b32 v48, v58, v4
  v_and_b32 v49, v58, v5
  v_and_b32 v50, v58, v6
  v_and_b32 v51, v58, v7
  s_waitcnt vmcnt(2)
  s_add_u32 s4, s75, s6
  buffer_load_dwordx4 v[244:247], v57, s[16:19], s4 offen
  s_add_u32 s6, s6, 8192
  s_and_b32 s6, s6, 262143
  v_mfma_f32_16x16x32_bf16 v[96:99], v[48:51], v[216:219], v[96:99]
  v_perm_b32 v58, v91, v91, s73
  v_and_b32 v52, v58, v4
  v_and_b32 v53, v58, v5
  v_and_b32 v54, v58, v6
  v_and_b32 v55, v58, v7
  s_waitcnt vmcnt(2)
  s_add_u32 s4, s75, s6
  buffer_load_dwordx4 v[248:251], v57, s[16:19], s4 offen
  s_add_u32 s6, s6, 8192
  s_and_b32 s6, s6, 262143
  v_mfma_f32_16x16x32_bf16 v[96:99], v[52:55], v[220:223], v[96:99]
  v_perm_b32 v58, v92, v92, s72
  v_and_b32 v40, v58, v4
  v_and_b32 v41, v58, v5
  v_and_b32 v42, v58, v6
  v_and_b32 v43, v58, v7
  s_waitcnt vmcnt(2)
  s_add_u32 s4, s75, s6
  buffer_load_dwordx4 v[252:255], v57, s[16:19], s4 offen
  s_add_u32 s6, s6, 8192
  s_and_b32 s6, s6, 262143
  v_mfma_f32_16x16x32_bf16 v[96:99], v[40:43], v[224:227], v[96:99]
  v_perm_b32 v58, v92, v92, s73
  v_and_b32 v44, v58, v4
  v_and_b32 v45, v58, v5
  v_and_b32 v46, v58, v6
  v_and_b32 v47, v58, v7
  s_nop 1
  v_mfma_f32_16x16x32_bf16 v[96:99], v[44:47], v[228:231], v[96:99]
  v_perm_b32 v58, v93, v93, s72
  v_and_b32 v48, v58, v4
  v_and_b32 v49, v58, v5
  v_and_b32 v50, v58, v6
  v_and_b32 v51, v58, v7
  s_nop 1
  v_mfma_f32_16x16x32_bf16 v[96:99], v[48:51], v[232:235], v[96:99]
  v_perm_b32 v58, v93, v93, s73
  v_and_b32 v52, v58, v4
  v_and_b32 v53, v58, v5
  v_and_b32 v54, v58, v6
  v_and_b32 v55, v58, v7
  s_nop 1
  v_mfma_f32_16x16x32_bf16 v[96:99], v[52:55], v[236:239], v[96:99]
  v_perm_b32 v58, v94, v94, s72
  v_and_b32 v40, v58, v4
  v_and_b32 v41, v58, v5
  v_and_b32 v42, v58, v6
  v_and_b32 v43, v58, v7
  s_nop 1
  v_mfma_f32_16x16x32_bf16 v[96:99], v[40:43], v[240:243], v[96:99]
  v_perm_b32 v58, v94, v94, s73
  v_and_b32 v44, v58, v4
  v_and_b32 v45, v58, v5
  v_and_b32 v46, v58, v6
  v_and_b32 v47, v58, v7
  s_waitcnt vmcnt(2)
  s_nop 0
  v_mfma_f32_16x16x32_bf16 v[96:99], v[44:47], v[244:247], v[96:99]
  v_perm_b32 v58, v95, v95, s72
  v_and_b32 v48, v58, v4
  v_and_b32 v49, v58, v5
  v_and_b32 v50, v58, v6
  v_and_b32 v51, v58, v7
  s_waitcnt vmcnt(1)
  s_nop 0
  v_mfma_f32_16x16x32_bf16 v[96:99], v[48:51], v[248:251], v[96:99]
  v_perm_b32 v58, v95, v95, s73
  v_and_b32 v52, v58, v4
  v_and_b32 v53, v58, v5
  v_and_b32 v54, v58, v6
  v_and_b32 v55, v58, v7
  s_waitcnt vmcnt(0)
  s_nop 0
  v_mfma_f32_16x16x32_bf16 v[96:99], v[52:55], v[252:255], v[96:99]
  s_lshr_b32 s4, s2, 6
  s_lshl_b32 s4, s4, 3
  s_and_b32 s5, s2, 7
  s_add_u32 s4, s4, s5
  s_bfe_u32 s5, s2, 0x30003
  s_cmp_eq_u32 s74, 3
  s_cbranch_scc1 L_pfo
  s_cmp_ge_u32 s4, 28
  s_cbranch_scc1 L_nopf
  s_cmp_eq_u32 s74, 2
  s_cbranch_scc1 L_pfd
  s_cmp_eq_u32 s74, 0
  s_cselect_b32 s24, s48, s50
  s_cselect_b32 s25, s49, s51
  s_mov_b32 s26, 1835008
  s_mov_b32 s27, 0x00020000
  v_mul_u32_u24 v58, 3584, v1
  s_mul_i32 s5, s5, 229376
  s_lshl_b32 s4, s4, 7
  s_add_u32 s4, s4, s5
  buffer_load_dword v63, v58, s[24:27], s4 offen
  s_branch L_nopf
L_pfd:
  v_lshlrev_b32 v58, 7, v1
  s_lshl_b32 s4, s4, 16
  s_lshl_b32 s5, s5, 13
  s_add_u32 s4, s4, s5
  buffer_load_dword v63, v58, s[32:35], s4 offen
  s_branch L_nopf
L_pfo:
  v_lshlrev_b32 v58, 7, v1
  s_lshl_b32 s4, s64, 17
  s_lshl_b32 s5, s69, 14
  s_add_u32 s4, s4, s5
  s_add_u32 s5, s4, 8192
  buffer_load_dword v63, v58, s[20:23], s4 offen
  buffer_load_dword v63, v58, s[20:23], s5 offen
L_nopf:
  v_mov_b32 v58, 22592
  v_mov_b32 v100, 0
  v_mov_b32 v101, 0
  v_mov_b32 v102, -1
  v_mov_b32 v103, 0
  ds_write_b128 v58, v[100:103]
  s_lshl_b32 s4, s74, 9
  v_add_u32 v57, s4, v60
  ds_write_b128 v57, v[96:99] offset:16384
  s_waitcnt lgkmcnt(0)
  s_barrier
  s_cmp_ge_u32 s2, 28
  s_cbranch_scc1 L_wo
  v_cmp_gt_u32 vcc, 8, v11
  v_mov_b32 v56, s50
  v_mov_b32 v57, s51
  v_mov_b32 v58, s48
  v_mov_b32 v59, s49
  v_cndmask_b32 v56, v56, v58, vcc
  v_cndmask_b32 v57, v57, v59, vcc
  s_mov_b32 s4, 458752
  v_mul_lo_u32 v58, v12, s4
  v_and_b32 v59, 7, v11
  v_lshl_add_u32 v58, v59, 4, v58
  s_lshl_b32 s4, s2, 7
  s_mul_i32 s5, s74, 114688
  s_add_u32 s4, s4, s5
  v_add_u32 v58, s4, v58
  v_mov_b32 v59, 0
  v_lshl_add_u64 v[56:57], v[56:57], 0, v[58:59]
  s_mov_b32 s18, 3584
  s_mov_b32 s19, 0
  v_lshlrev_b32 v61, 14, v12
  v_lshl_add_u32 v61, v11, 4, v61
  s_lshl_b32 s4, s2, 16
  s_lshl_b32 s5, s74, 8
  s_add_u32 s4, s4, s5
  global_load_dwordx4 v[128:131], v[56:57], off
  v_lshl_add_u64 v[56:57], v[56:57], 0, s[18:19]
  global_load_dwordx4 v[132:135], v[56:57], off
  v_lshl_add_u64 v[56:57], v[56:57], 0, s[18:19]
  v_lshrrev_b32 v58, 3, v11
  v_lshlrev_b32 v58, 10, v58
  v_lshl_add_u32 v58, v12, 8, v58
  s_mul_i32 s5, s74, 4160
  v_add_u32 v58, s5, v58
  ds_read_b128 v[16:19], v58 offset:0
  ds_read_b128 v[20:23], v58 offset:2048
  s_waitcnt lgkmcnt(0)
  v_perm_b32 v59, v16, v16, s72
  v_and_b32 v40, v59, v4
  v_and_b32 v41, v59, v5
  v_and_b32 v42, v59, v6
  v_and_b32 v43, v59, v7
  v_perm_b32 v59, v20, v20, s72
  v_and_b32 v44, v59, v4
  v_and_b32 v45, v59, v5
  v_and_b32 v46, v59, v6
  v_and_b32 v47, v59, v7
  s_waitcnt vmcnt(1)
  global_load_dwordx4 v[136:139], v[56:57], off
  v_lshl_add_u64 v[56:57], v[56:57], 0, s[18:19]
  v_mfma_f32_16x16x32_bf16 v[24:27], v[40:43], v[128:131], 0
  v_mfma_f32_16x16x32_bf16 v[28:31], v[44:47], v[128:131], 0
  v_perm_b32 v59, v16, v16, s73
  v_and_b32 v48, v59, v4
  v_and_b32 v49, v59, v5
  v_and_b32 v50, v59, v6
  v_and_b32 v51, v59, v7
  v_perm_b32 v59, v20, v20, s73
  v_and_b32 v52, v59, v4
  v_and_b32 v53, v59, v5
  v_and_b32 v54, v59, v6
  v_and_b32 v55, v59, v7
  s_waitcnt vmcnt(1)
  global_load_dwordx4 v[140:143], v[56:57], off
  v_lshl_add_u64 v[56:57], v[56:57], 0, s[18:19]
  v_mfma_f32_16x16x32_bf16 v[24:27], v[48:51], v[132:135], v[24:27]
  v_mfma_f32_16x16x32_bf16 v[28:31], v[52:55], v[132:135], v[28:31]
  v_perm_b32 v59, v17, v17, s72
  v_and_b32 v40, v59, v4
  v_and_b32 v41, v59, v5
  v_and_b32 v42, v59, v6
  v_and_b32 v43, v59, v7
  v_perm_b32 v59, v21, v21, s72
  v_and_b32 v44, v59, v4
  v_and_b32 v45, v59, v5
  v_and_b32 v46, v59, v6
  v_and_b32 v47, v59, v7
  s_waitcnt vmcnt(1)
  global_load_dwordx4 v[144:147], v[56:57], off
  v_lshl_add_u64 v[56:57], v[56:57], 0, s[18:19]
  v_mfma_f32_16x16x32_bf16 v[24:27], v[40:43], v[136:139], v[24:27]
  v_mfma_f32_16x16x32_bf16 v[28:31], v[44:47], v[136:139], v[28:31]
  v_perm_b32 v59, v17, v17, s73
  v_and_b32 v48, v59, v4
  v_and_b32 v49, v59, v5
  v_and_b32 v50, v59, v6
  v_and_b32 v51, v59, v7
  v_perm_b32 v59, v21, v21, s73
  v_and_b32 v52, v59, v4
  v_and_b32 v53, v59, v5
  v_and_b32 v54, v59, v6
  v_and_b32 v55, v59, v7
  s_waitcnt vmcnt(1)
  global_load_dwordx4 v[148:151], v[56:57], off
  v_lshl_add_u64 v[56:57], v[56:57], 0, s[18:19]
  v_mfma_f32_16x16x32_bf16 v[24:27], v[48:51], v[140:143], v[24:27]
  v_mfma_f32_16x16x32_bf16 v[28:31], v[52:55], v[140:143], v[28:31]
  v_perm_b32 v59, v18, v18, s72
  v_and_b32 v40, v59, v4
  v_and_b32 v41, v59, v5
  v_and_b32 v42, v59, v6
  v_and_b32 v43, v59, v7
  v_perm_b32 v59, v22, v22, s72
  v_and_b32 v44, v59, v4
  v_and_b32 v45, v59, v5
  v_and_b32 v46, v59, v6
  v_and_b32 v47, v59, v7
  s_waitcnt vmcnt(1)
  global_load_dwordx4 v[152:155], v[56:57], off
  v_lshl_add_u64 v[56:57], v[56:57], 0, s[18:19]
  v_mfma_f32_16x16x32_bf16 v[24:27], v[40:43], v[144:147], v[24:27]
  v_mfma_f32_16x16x32_bf16 v[28:31], v[44:47], v[144:147], v[28:31]
  v_perm_b32 v59, v18, v18, s73
  v_and_b32 v48, v59, v4
  v_and_b32 v49, v59, v5
  v_and_b32 v50, v59, v6
  v_and_b32 v51, v59, v7
  v_perm_b32 v59, v22, v22, s73
  v_and_b32 v52, v59, v4
  v_and_b32 v53, v59, v5
  v_and_b32 v54, v59, v6
  v_and_b32 v55, v59, v7
  s_waitcnt vmcnt(1)
  global_load_dwordx4 v[156:159], v[56:57], off
  v_lshl_add_u64 v[56:57], v[56:57], 0, s[18:19]
  v_mfma_f32_16x16x32_bf16 v[24:27], v[48:51], v[148:151], v[24:27]
  v_mfma_f32_16x16x32_bf16 v[28:31], v[52:55], v[148:151], v[28:31]
  v_perm_b32 v59, v19, v19, s72
  v_and_b32 v40, v59, v4
  v_and_b32 v41, v59, v5
  v_and_b32 v42, v59, v6
  v_and_b32 v43, v59, v7
  v_perm_b32 v59, v23, v23, s72
  v_and_b32 v44, v59, v4
  v_and_b32 v45, v59, v5
  v_and_b32 v46, v59, v6
  v_and_b32 v47, v59, v7
  s_waitcnt vmcnt(1)
  global_load_dwordx4 v[160:163], v[56:57], off
  v_lshl_add_u64 v[56:57], v[56:57], 0, s[18:19]
  v_mfma_f32_16x16x32_bf16 v[24:27], v[40:43], v[152:155], v[24:27]
  v_mfma_f32_16x16x32_bf16 v[28:31], v[44:47], v[152:155], v[28:31]
  v_perm_b32 v59, v19, v19, s73
  v_and_b32 v48, v59, v4
  v_and_b32 v49, v59, v5
  v_and_b32 v50, v59, v6
  v_and_b32 v51, v59, v7
  v_perm_b32 v59, v23, v23, s73
  v_and_b32 v52, v59, v4
  v_and_b32 v53, v59, v5
  v_and_b32 v54, v59, v6
  v_and_b32 v55, v59, v7
  s_waitcnt vmcnt(1)
  global_load_dwordx4 v[164:167], v[56:57], off
  v_lshl_add_u64 v[56:57], v[56:57], 0, s[18:19]
  v_mfma_f32_16x16x32_bf16 v[24:27], v[48:51], v[156:159], v[24:27]
  v_mfma_f32_16x16x32_bf16 v[28:31], v[52:55], v[156:159], v[28:31]
  ds_read_b128 v[16:19], v58 offset:16
  ds_read_b128 v[20:23], v58 offset:2064
  s_waitcnt lgkmcnt(0)
  v_perm_b32 v59, v16, v16, s72
  v_and_b32 v40, v59, v4
  v_and_b32 v41, v59, v5
  v_and_b32 v42, v59, v6
  v_and_b32 v43, v59, v7
  v_perm_b32 v59, v20, v20, s72
  v_and_b32 v44, v59, v4
  v_and_b32 v45, v59, v5
  v_and_b32 v46, v59, v6
  v_and_b32 v47, v59, v7
  s_waitcnt vmcnt(1)
  global_load_dwordx4 v[168:171], v[56:57], off
  v_lshl_add_u64 v[56:57], v[56:57], 0, s[18:19]
  v_mfma_f32_16x16x32_bf16 v[24:27], v[40:43], v[160:163], v[24:27]
  v_mfma_f32_16x16x32_bf16 v[28:31], v[44:47], v[160:163], v[28:31]
  v_perm_b32 v59, v16, v16, s73
  v_and_b32 v48, v59, v4
  v_and_b32 v49, v59, v5
  v_and_b32 v50, v59, v6
  v_and_b32 v51, v59, v7
  v_perm_b32 v59, v20, v20, s73
  v_and_b32 v52, v59, v4
  v_and_b32 v53, v59, v5
  v_and_b32 v54, v59, v6
  v_and_b32 v55, v59, v7
  s_waitcnt vmcnt(1)
  global_load_dwordx4 v[172:175], v[56:57], off
  v_lshl_add_u64 v[56:57], v[56:57], 0, s[18:19]
  v_mfma_f32_16x16x32_bf16 v[24:27], v[48:51], v[164:167], v[24:27]
  v_mfma_f32_16x16x32_bf16 v[28:31], v[52:55], v[164:167], v[28:31]
  v_perm_b32 v59, v17, v17, s72
  v_and_b32 v40, v59, v4
  v_and_b32 v41, v59, v5
  v_and_b32 v42, v59, v6
  v_and_b32 v43, v59, v7
  v_perm_b32 v59, v21, v21, s72
  v_and_b32 v44, v59, v4
  v_and_b32 v45, v59, v5
  v_and_b32 v46, v59, v6
  v_and_b32 v47, v59, v7
  s_waitcnt vmcnt(1)
  global_load_dwordx4 v[176:179], v[56:57], off
  v_lshl_add_u64 v[56:57], v[56:57], 0, s[18:19]
  v_mfma_f32_16x16x32_bf16 v[24:27], v[40:43], v[168:171], v[24:27]
  v_mfma_f32_16x16x32_bf16 v[28:31], v[44:47], v[168:171], v[28:31]
  v_perm_b32 v59, v17, v17, s73
  v_and_b32 v48, v59, v4
  v_and_b32 v49, v59, v5
  v_and_b32 v50, v59, v6
  v_and_b32 v51, v59, v7
  v_perm_b32 v59, v21, v21, s73
  v_and_b32 v52, v59, v4
  v_and_b32 v53, v59, v5
  v_and_b32 v54, v59, v6
  v_and_b32 v55, v59, v7
  s_waitcnt vmcnt(1)
  global_load_dwordx4 v[180:183], v[56:57], off
  v_lshl_add_u64 v[56:57], v[56:57], 0, s[18:19]
  v_mfma_f32_16x16x32_bf16 v[24:27], v[48:51], v[172:175], v[24:27]
  v_mfma_f32_16x16x32_bf16 v[28:31], v[52:55], v[172:175], v[28:31]
  v_perm_b32 v59, v18, v18, s72
  v_and_b32 v40, v59, v4
  v_and_b32 v41, v59, v5
  v_and_b32 v42, v59, v6
  v_and_b32 v43, v59, v7
  v_perm_b32 v59, v22, v22, s72
  v_and_b32 v44, v59, v4
  v_and_b32 v45, v59, v5
  v_and_b32 v46, v59, v6
  v_and_b32 v47, v59, v7
  s_waitcnt vmcnt(1)
  global_load_dwordx4 v[184:187], v[56:57], off
  v_lshl_add_u64 v[56:57], v[56:57], 0, s[18:19]
  v_mfma_f32_16x16x32_bf16 v[24:27], v[40:43], v[176:179], v[24:27]
  v_mfma_f32_16x16x32_bf16 v[28:31], v[44:47], v[176:179], v[28:31]
  v_perm_b32 v59, v18, v18, s73
  v_and_b32 v48, v59, v4
  v_and_b32 v49, v59, v5
  v_and_b32 v50, v59, v6
  v_and_b32 v51, v59, v7
  v_perm_b32 v59, v22, v22, s73
  v_and_b32 v52, v59, v4
  v_and_b32 v53, v59, v5
  v_and_b32 v54, v59, v6
  v_and_b32 v55, v59, v7
  s_waitcnt vmcnt(1)
  global_load_dwordx4 v[188:191], v[56:57], off
  v_lshl_add_u64 v[56:57], v[56:57], 0, s[18:19]
  v_mfma_f32_16x16x32_bf16 v[24:27], v[48:51], v[180:183], v[24:27]
  v_mfma_f32_16x16x32_bf16 v[28:31], v[52:55], v[180:183], v[28:31]
  v_perm_b32 v59, v19, v19, s72
  v_and_b32 v40, v59, v4
  v_and_b32 v41, v59, v5
  v_and_b32 v42, v59, v6
  v_and_b32 v43, v59, v7
  v_perm_b32 v59, v23, v23, s72
  v_and_b32 v44, v59, v4
  v_and_b32 v45, v59, v5
  v_and_b32 v46, v59, v6
  v_and_b32 v47, v59, v7
  s_waitcnt vmcnt(1)
  global_load_dwordx4 v[192:195], v[56:57], off
  v_lshl_add_u64 v[56:57], v[56:57], 0, s[18:19]
  v_mfma_f32_16x16x32_bf16 v[24:27], v[40:43], v[184:187], v[24:27]
  v_mfma_f32_16x16x32_bf16 v[28:31], v[44:47], v[184:187], v[28:31]
  v_perm_b32 v59, v19, v19, s73
  v_and_b32 v48, v59, v4
  v_and_b32 v49, v59, v5
  v_and_b32 v50, v59, v6
  v_and_b32 v51, v59, v7
  v_perm_b32 v59, v23, v23, s73
  v_and_b32 v52, v59, v4
  v_and_b32 v53, v59, v5
  v_and_b32 v54, v59, v6
  v_and_b32 v55, v59, v7
  s_waitcnt vmcnt(1)
  global_load_dwordx4 v[196:199], v[56:57], off
  v_lshl_add_u64 v[56:57], v[56:57], 0, s[18:19]
  v_mfma_f32_16x16x32_bf16 v[24:27], v[48:51], v[188:191], v[24:27]
  v_mfma_f32_16x16x32_bf16 v[28:31], v[52:55], v[188:191], v[28:31]
  ds_read_b128 v[16:19], v58 offset:32
  ds_read_b128 v[20:23], v58 offset:2080
  s_waitcnt lgkmcnt(0)
  v_perm_b32 v59, v16, v16, s72
  v_and_b32 v40, v59, v4
  v_and_b32 v41, v59, v5
  v_and_b32 v42, v59, v6
  v_and_b32 v43, v59, v7
  v_perm_b32 v59, v20, v20, s72
  v_and_b32 v44, v59, v4
  v_and_b32 v45, v59, v5
  v_and_b32 v46, v59, v6
  v_and_b32 v47, v59, v7
  s_waitcnt vmcnt(1)
  global_load_dwordx4 v[200:203], v[56:57], off
  v_lshl_add_u64 v[56:57], v[56:57], 0, s[18:19]
  v_mfma_f32_16x16x32_bf16 v[24:27], v[40:43], v[192:195], v[24:27]
  v_mfma_f32_16x16x32_bf16 v[28:31], v[44:47], v[192:195], v[28:31]
  v_perm_b32 v59, v16, v16, s73
  v_and_b32 v48, v59, v4
  v_and_b32 v49, v59, v5
  v_and_b32 v50, v59, v6
  v_and_b32 v51, v59, v7
  v_perm_b32 v59, v20, v20, s73
  v_and_b32 v52, v59, v4
  v_and_b32 v53, v59, v5
  v_and_b32 v54, v59, v6
  v_and_b32 v55, v59, v7
  s_waitcnt vmcnt(1)
  global_load_dwordx4 v[204:207], v[56:57], off
  v_lshl_add_u64 v[56:57], v[56:57], 0, s[18:19]
  v_mfma_f32_16x16x32_bf16 v[24:27], v[48:51], v[196:199], v[24:27]
  v_mfma_f32_16x16x32_bf16 v[28:31], v[52:55], v[196:199], v[28:31]
  v_perm_b32 v59, v17, v17, s72
  v_and_b32 v40, v59, v4
  v_and_b32 v41, v59, v5
  v_and_b32 v42, v59, v6
  v_and_b32 v43, v59, v7
  v_perm_b32 v59, v21, v21, s72
  v_and_b32 v44, v59, v4
  v_and_b32 v45, v59, v5
  v_and_b32 v46, v59, v6
  v_and_b32 v47, v59, v7
  s_waitcnt vmcnt(1)
  global_load_dwordx4 v[208:211], v[56:57], off
  v_lshl_add_u64 v[56:57], v[56:57], 0, s[18:19]
  v_mfma_f32_16x16x32_bf16 v[24:27], v[40:43], v[200:203], v[24:27]
  v_mfma_f32_16x16x32_bf16 v[28:31], v[44:47], v[200:203], v[28:31]
  v_perm_b32 v59, v17, v17, s73
  v_and_b32 v48, v59, v4
  v_and_b32 v49, v59, v5
  v_and_b32 v50, v59, v6
  v_and_b32 v51, v59, v7
  v_perm_b32 v59, v21, v21, s73
  v_and_b32 v52, v59, v4
  v_and_b32 v53, v59, v5
  v_and_b32 v54, v59, v6
  v_and_b32 v55, v59, v7
  s_waitcnt vmcnt(1)
  global_load_dwordx4 v[212:215], v[56:57], off
  v_lshl_add_u64 v[56:57], v[56:57], 0, s[18:19]
  v_mfma_f32_16x16x32_bf16 v[24:27], v[48:51], v[204:207], v[24:27]
  v_mfma_f32_16x16x32_bf16 v[28:31], v[52:55], v[204:207], v[28:31]
  v_perm_b32 v59, v18, v18, s72
  v_and_b32 v40, v59, v4
  v_and_b32 v41, v59, v5
  v_and_b32 v42, v59, v6
  v_and_b32 v43, v59, v7
  v_perm_b32 v59, v22, v22, s72
  v_and_b32 v44, v59, v4
  v_and_b32 v45, v59, v5
  v_and_b32 v46, v59, v6
  v_and_b32 v47, v59, v7
  s_waitcnt vmcnt(1)
  global_load_dwordx4 v[216:219], v[56:57], off
  v_lshl_add_u64 v[56:57], v[56:57], 0, s[18:19]
  v_mfma_f32_16x16x32_bf16 v[24:27], v[40:43], v[208:211], v[24:27]
  v_mfma_f32_16x16x32_bf16 v[28:31], v[44:47], v[208:211], v[28:31]
  v_perm_b32 v59, v18, v18, s73
  v_and_b32 v48, v59, v4
  v_and_b32 v49, v59, v5
  v_and_b32 v50, v59, v6
  v_and_b32 v51, v59, v7
  v_perm_b32 v59, v22, v22, s73
  v_and_b32 v52, v59, v4
  v_and_b32 v53, v59, v5
  v_and_b32 v54, v59, v6
  v_and_b32 v55, v59, v7
  s_waitcnt vmcnt(1)
  global_load_dwordx4 v[220:223], v[56:57], off
  v_lshl_add_u64 v[56:57], v[56:57], 0, s[18:19]
  v_mfma_f32_16x16x32_bf16 v[24:27], v[48:51], v[212:215], v[24:27]
  v_mfma_f32_16x16x32_bf16 v[28:31], v[52:55], v[212:215], v[28:31]
  v_perm_b32 v59, v19, v19, s72
  v_and_b32 v40, v59, v4
  v_and_b32 v41, v59, v5
  v_and_b32 v42, v59, v6
  v_and_b32 v43, v59, v7
  v_perm_b32 v59, v23, v23, s72
  v_and_b32 v44, v59, v4
  v_and_b32 v45, v59, v5
  v_and_b32 v46, v59, v6
  v_and_b32 v47, v59, v7
  s_waitcnt vmcnt(1)
  global_load_dwordx4 v[224:227], v[56:57], off
  v_lshl_add_u64 v[56:57], v[56:57], 0, s[18:19]
  v_mfma_f32_16x16x32_bf16 v[24:27], v[40:43], v[216:219], v[24:27]
  v_mfma_f32_16x16x32_bf16 v[28:31], v[44:47], v[216:219], v[28:31]
  v_perm_b32 v59, v19, v19, s73
  v_and_b32 v48, v59, v4
  v_and_b32 v49, v59, v5
  v_and_b32 v50, v59, v6
  v_and_b32 v51, v59, v7
  v_perm_b32 v59, v23, v23, s73
  v_and_b32 v52, v59, v4
  v_and_b32 v53, v59, v5
  v_and_b32 v54, v59, v6
  v_and_b32 v55, v59, v7
  s_waitcnt vmcnt(1)
  global_load_dwordx4 v[228:231], v[56:57], off
  v_lshl_add_u64 v[56:57], v[56:57], 0, s[18:19]
  v_mfma_f32_16x16x32_bf16 v[24:27], v[48:51], v[220:223], v[24:27]
  v_mfma_f32_16x16x32_bf16 v[28:31], v[52:55], v[220:223], v[28:31]
  ds_read_b128 v[16:19], v58 offset:48
  ds_read_b128 v[20:23], v58 offset:2096
  s_waitcnt lgkmcnt(0)
  v_perm_b32 v59, v16, v16, s72
  v_and_b32 v40, v59, v4
  v_and_b32 v41, v59, v5
  v_and_b32 v42, v59, v6
  v_and_b32 v43, v59, v7
  v_perm_b32 v59, v20, v20, s72
  v_and_b32 v44, v59, v4
  v_and_b32 v45, v59, v5
  v_and_b32 v46, v59, v6
  v_and_b32 v47, v59, v7
  s_waitcnt vmcnt(1)
  global_load_dwordx4 v[232:235], v[56:57], off
  v_lshl_add_u64 v[56:57], v[56:57], 0, s[18:19]
  v_mfma_f32_16x16x32_bf16 v[24:27], v[40:43], v[224:227], v[24:27]
  v_mfma_f32_16x16x32_bf16 v[28:31], v[44:47], v[224:227], v[28:31]
  v_perm_b32 v59, v16, v16, s73
  v_and_b32 v48, v59, v4
  v_and_b32 v49, v59, v5
  v_and_b32 v50, v59, v6
  v_and_b32 v51, v59, v7
  v_perm_b32 v59, v20, v20, s73
  v_and_b32 v52, v59, v4
  v_and_b32 v53, v59, v5
  v_and_b32 v54, v59, v6
  v_and_b32 v55, v59, v7
  s_waitcnt vmcnt(1)
  global_load_dwordx4 v[236:239], v[56:57], off
  v_lshl_add_u64 v[56:57], v[56:57], 0, s[18:19]
  v_mfma_f32_16x16x32_bf16 v[24:27], v[48:51], v[228:231], v[24:27]
  v_mfma_f32_16x16x32_bf16 v[28:31], v[52:55], v[228:231], v[28:31]
  v_perm_b32 v59, v17, v17, s72
  v_and_b32 v40, v59, v4
  v_and_b32 v41, v59, v5
  v_and_b32 v42, v59, v6
  v_and_b32 v43, v59, v7
  v_perm_b32 v59, v21, v21, s72
  v_and_b32 v44, v59, v4
  v_and_b32 v45, v59, v5
  v_and_b32 v46, v59, v6
  v_and_b32 v47, v59, v7
  s_waitcnt vmcnt(1)
  global_load_dwordx4 v[240:243], v[56:57], off
  v_lshl_add_u64 v[56:57], v[56:57], 0, s[18:19]
  v_mfma_f32_16x16x32_bf16 v[24:27], v[40:43], v[232:235], v[24:27]
  v_mfma_f32_16x16x32_bf16 v[28:31], v[44:47], v[232:235], v[28:31]
  v_perm_b32 v59, v17, v17, s73
  v_and_b32 v48, v59, v4
  v_and_b32 v49, v59, v5
  v_and_b32 v50, v59, v6
  v_and_b32 v51, v59, v7
  v_perm_b32 v59, v21, v21, s73
  v_and_b32 v52, v59, v4
  v_and_b32 v53, v59, v5
  v_and_b32 v54, v59, v6
  v_and_b32 v55, v59, v7
  s_waitcnt vmcnt(1)
  global_load_dwordx4 v[244:247], v[56:57], off
  v_lshl_add_u64 v[56:57], v[56:57], 0, s[18:19]
  v_mfma_f32_16x16x32_bf16 v[24:27], v[48:51], v[236:239], v[24:27]
  v_mfma_f32_16x16x32_bf16 v[28:31], v[52:55], v[236:239], v[28:31]
  v_perm_b32 v59, v18, v18, s72
  v_and_b32 v40, v59, v4
  v_and_b32 v41, v59, v5
  v_and_b32 v42, v59, v6
  v_and_b32 v43, v59, v7
  v_perm_b32 v59, v22, v22, s72
  v_and_b32 v44, v59, v4
  v_and_b32 v45, v59, v5
  v_and_b32 v46, v59, v6
  v_and_b32 v47, v59, v7
  s_waitcnt vmcnt(1)
  global_load_dwordx4 v[248:251], v[56:57], off
  v_lshl_add_u64 v[56:57], v[56:57], 0, s[18:19]
  v_mfma_f32_16x16x32_bf16 v[24:27], v[40:43], v[240:243], v[24:27]
  v_mfma_f32_16x16x32_bf16 v[28:31], v[44:47], v[240:243], v[28:31]
  v_perm_b32 v59, v18, v18, s73
  v_and_b32 v48, v59, v4
  v_and_b32 v49, v59, v5
  v_and_b32 v50, v59, v6
  v_and_b32 v51, v59, v7
  v_perm_b32 v59, v22, v22, s73
  v_and_b32 v52, v59, v4
  v_and_b32 v53, v59, v5
  v_and_b32 v54, v59, v6
  v_and_b32 v55, v59, v7
  s_waitcnt vmcnt(1)
  global_load_dwordx4 v[252:255], v[56:57], off
  v_lshl_add_u64 v[56:57], v[56:57], 0, s[18:19]
  v_mfma_f32_16x16x32_bf16 v[24:27], v[48:51], v[244:247], v[24:27]
  v_mfma_f32_16x16x32_bf16 v[28:31], v[52:55], v[244:247], v[28:31]
  v_perm_b32 v59, v19, v19, s72
  v_and_b32 v40, v59, v4
  v_and_b32 v41, v59, v5
  v_and_b32 v42, v59, v6
  v_and_b32 v43, v59, v7
  v_perm_b32 v59, v23, v23, s72
  v_and_b32 v44, v59, v4
  v_and_b32 v45, v59, v5
  v_and_b32 v46, v59, v6
  v_and_b32 v47, v59, v7
  s_waitcnt vmcnt(1)
  buffer_load_dwordx4 v[64:67], v61, s[32:35], s4 offen offset:0
  v_mfma_f32_16x16x32_bf16 v[24:27], v[40:43], v[248:251], v[24:27]
  v_mfma_f32_16x16x32_bf16 v[28:31], v[44:47], v[248:251], v[28:31]
  v_perm_b32 v59, v19, v19, s73
  v_and_b32 v48, v59, v4
  v_and_b32 v49, v59, v5
  v_and_b32 v50, v59, v6
  v_and_b32 v51, v59, v7
  v_perm_b32 v59, v23, v23, s73
  v_and_b32 v52, v59, v4
  v_and_b32 v53, v59, v5
  v_and_b32 v54, v59, v6
  v_and_b32 v55, v59, v7
  s_waitcnt vmcnt(1)
  buffer_load_dwordx4 v[68:71], v61, s[32:35], s4 offen offset:1024
  v_mfma_f32_16x16x32_bf16 v[24:27], v[48:51], v[252:255], v[24:27]
  v_mfma_f32_16x16x32_bf16 v[28:31], v[52:55], v[252:255], v[28:31]
  v_lshlrev_b32 v58, 5, v1
  s_lshl_b32 s5, s74, 11
  v_add_u32 v59, s5, v58
  s_nop 3
  ds_write_b128 v59, v[24:27] offset:24576
  ds_write_b128 v59, v[28:31] offset:24592
  v_mov_b32 v59, 22592
  v_mov_b32 v62, 1
  s_waitcnt lgkmcnt(0)
  s_mov_b64 exec, 1
  ds_add_u32 v59, v62
  s_mov_b64 exec, -1
  s_waitcnt vmcnt(1)
  buffer_load_dwordx4 v[72:75], v61, s[32:35], s4 offen offset:2048
  s_waitcnt vmcnt(1)
  buffer_load_dwordx4 v[76:79], v61, s[32:35], s4 offen offset:3072
  s_add_u32 s4, s4, 4096
  s_waitcnt vmcnt(1)
  buffer_load_dwordx4 v[80:83], v61, s[32:35], s4 offen offset:0
  s_waitcnt vmcnt(1)
  buffer_load_dwordx4 v[84:87], v61, s[32:35], s4 offen offset:1024
  s_waitcnt vmcnt(1)
  buffer_load_dwordx4 v[88:91], v61, s[32:35], s4 offen offset:2048
  s_waitcnt vmcnt(1)
  buffer_load_dwordx4 v[92:95], v61, s[32:35], s4 offen offset:3072
  s_add_u32 s4, s4, 4096
  s_waitcnt vmcnt(1)
  buffer_load_dwordx4 v[96:99], v61, s[32:35], s4 offen offset:0
  s_waitcnt vmcnt(1)
  buffer_load_dwordx4 v[100:103], v61, s[32:35], s4 offen offset:1024
  s_waitcnt vmcnt(1)
  buffer_load_dwordx4 v[104:107], v61, s[32:35], s4 offen offset:2048
  s_waitcnt vmcnt(1)
  buffer_load_dwordx4 v[108:111], v61, s[32:35], s4 offen offset:3072
  s_add_u32 s4, s4, 4096
  s_waitcnt vmcnt(1)
  buffer_load_dwordx4 v[112:115], v61, s[32:35], s4 offen offset:0
  s_waitcnt vmcnt(1)
  buffer_load_dwordx4 v[116:119], v61, s[32:35], s4 offen offset:1024
  s_waitcnt vmcnt(1)
  buffer_load_dwordx4 v[120:123], v61, s[32:35], s4 offen offset:2048
  s_waitcnt vmcnt(1)
  buffer_load_dwordx4 v[124:127], v61, s[32:35], s4 offen offset:3072
  s_add_u32 s4, s4, 4096
L_fsync:
  ds_read_b32 v62, v59
  s_waitcnt lgkmcnt(0)
  v_readfirstlane_b32 s5, v62
  s_nop 1
  s_cmp_ge_u32 s5, 4
  s_cbranch_scc1 L_fgo
  s_sleep 2
  s_branch L_fsync
L_fgo:
  ds_read_b128 v[128:131], v58 offset:24576
  ds_read_b128 v[132:135], v58 offset:24592
  ds_read_b128 v[136:139], v58 offset:26624
  ds_read_b128 v[140:143], v58 offset:26640
  ds_read_b128 v[144:147], v58 offset:28672
  ds_read_b128 v[148:151], v58 offset:28688
  ds_read_b128 v[152:155], v58 offset:30720
  ds_read_b128 v[156:159], v58 offset:30736
  s_waitcnt lgkmcnt(0)
  v_add_f32 v128, v128, v136
  v_add_f32 v144, v144, v152
  v_add_f32 v129, v129, v137
  v_add_f32 v145, v145, v153
  v_add_f32 v130, v130, v138
  v_add_f32 v146, v146, v154
  v_add_f32 v131, v131, v139
  v_add_f32 v147, v147, v155
  v_add_f32 v132, v132, v140
  v_add_f32 v148, v148, v156
  v_add_f32 v133, v133, v141
  v_add_f32 v149, v149, v157
  v_add_f32 v134, v134, v142
  v_add_f32 v150, v150, v158
  v_add_f32 v135, v135, v143
  v_add_f32 v151, v151, v159
  v_add_f32 v128, v128, v144
  v_add_f32 v129, v129, v145
  v_add_f32 v130, v130, v146
  v_add_f32 v131, v131, v147
  v_add_f32 v132, v132, v148
  v_add_f32 v133, v133, v149
  v_add_f32 v134, v134, v150
  v_add_f32 v135, v135, v151
  v_cvt_pk_bf16_f32 v128, 0, v128
  v_cvt_pk_bf16_f32 v129, 0, v129
  v_cvt_pk_bf16_f32 v130, 0, v130
  v_cvt_pk_bf16_f32 v131, 0, v131
  v_cvt_pk_bf16_f32 v132, 0, v132
  v_cvt_pk_bf16_f32 v133, 0, v133
  v_cvt_pk_bf16_f32 v134, 0, v134
  v_cvt_pk_bf16_f32 v135, 0, v135
  v_mov_b32_dpp v136, v128 row_ror:8 row_mask:0xf bank_mask:0xf
  v_mov_b32_dpp v137, v129 row_ror:8 row_mask:0xf bank_mask:0xf
  v_mov_b32_dpp v138, v130 row_ror:8 row_mask:0xf bank_mask:0xf
  v_mov_b32_dpp v139, v131 row_ror:8 row_mask:0xf bank_mask:0xf
  v_mov_b32_dpp v140, v132 row_ror:8 row_mask:0xf bank_mask:0xf
  v_mov_b32_dpp v141, v133 row_ror:8 row_mask:0xf bank_mask:0xf
  v_mov_b32_dpp v142, v134 row_ror:8 row_mask:0xf bank_mask:0xf
  v_mov_b32_dpp v143, v135 row_ror:8 row_mask:0xf bank_mask:0xf
  v_mul_f32 v144, s70, v128
  v_mul_f32 v145, s70, v129
  v_mul_f32 v146, s70, v130
  v_mul_f32 v147, s70, v131
  v_mul_f32 v148, s70, v132
  v_mul_f32 v149, s70, v133
  v_mul_f32 v150, s70, v134
  v_mul_f32 v151, s70, v135
  v_exp_f32 v144, -v144
  v_exp_f32 v145, -v145
  v_exp_f32 v146, -v146
  v_exp_f32 v147, -v147
  v_exp_f32 v148, -v148
  v_exp_f32 v149, -v149
  v_exp_f32 v150, -v150
  v_exp_f32 v151, -v151
  v_add_f32 v144, 1.0, v144
  v_add_f32 v145, 1.0, v145
  v_add_f32 v146, 1.0, v146
  v_add_f32 v147, 1.0, v147
  v_add_f32 v148, 1.0, v148
  v_add_f32 v149, 1.0, v149
  v_add_f32 v150, 1.0, v150
  v_add_f32 v151, 1.0, v151
  v_rcp_f32 v144, v144
  v_rcp_f32 v145, v145
  v_rcp_f32 v146, v146
  v_rcp_f32 v147, v147
  v_rcp_f32 v148, v148
  v_rcp_f32 v149, v149
  v_rcp_f32 v150, v150
  v_rcp_f32 v151, v151
  v_mul_f32 v128, v128, v144
  v_mul_f32 v129, v129, v145
  v_mul_f32 v130, v130, v146
  v_mul_f32 v131, v131, v147
  v_mul_f32 v132, v132, v148
  v_mul_f32 v133, v133, v149
  v_mul_f32 v134, v134, v150
  v_mul_f32 v135, v135, v151
  v_cvt_pk_bf16_f32 v128, 0, v128
  v_cvt_pk_bf16_f32 v129, 0, v129
  v_cvt_pk_bf16_f32 v130, 0, v130
  v_cvt_pk_bf16_f32 v131, 0, v131
  v_cvt_pk_bf16_f32 v132, 0, v132
  v_cvt_pk_bf16_f32 v133, 0, v133
  v_cvt_pk_bf16_f32 v134, 0, v134
  v_cvt_pk_bf16_f32 v135, 0, v135
  v_mul_f32 v128, v128, v136
  v_mul_f32 v129, v129, v137
  v_mul_f32 v130, v130, v138
  v_mul_f32 v131, v131, v139
  v_mul_f32 v132, v132, v140
  v_mul_f32 v133, v133, v141
  v_mul_f32 v134, v134, v142
  v_mul_f32 v135, v135, v143
  v_cvt_pk_bf16_f32 v144, v128, v129
  v_cvt_pk_bf16_f32 v145, v130, v131
  v_cvt_pk_bf16_f32 v146, v132, v133
  v_cvt_pk_bf16_f32 v147, v134, v135
  s_lshl_b32 s5, s74, 12
  v_lshrrev_b32 v58, 1, v12
  v_lshlrev_b32 v58, 7, v58
  v_lshrrev_b32 v59, 1, v60
  v_add_u32 v58, v58, v59
  v_mov_b32 v59, 1024
  v_cndmask_b32 v58, v59, v58, vcc
  v_add_u32 v58, s5, v58
  ds_write_b64 v58, v[144:145] offset:0
  ds_write_b64 v58, v[146:147] offset:256
  v_lshrrev_b32 v58, 3, v11
  v_lshlrev_b32 v58, 7, v58
  v_lshl_add_u32 v58, v12, 5, v58
  v_add_u32 v58, s5, v58
  s_waitcnt lgkmcnt(0)
  ds_read_b128 v[128:131], v58 offset:0
  ds_read_b128 v[132:135], v58 offset:16
  ds_read_b128 v[136:139], v58 offset:256
  ds_read_b128 v[140:143], v58 offset:272
  s_waitcnt vmcnt(0) lgkmcnt(0)
  v_perm_b32 v59, v128, v128, s72
  v_and_b32 v40, v59, v4
  v_and_b32 v41, v59, v5
  v_and_b32 v42, v59, v6
  v_and_b32 v43, v59, v7
  v_perm_b32 v59, v136, v136, s72
  v_and_b32 v44, v59, v4
  v_and_b32 v45, v59, v5
  v_and_b32 v46, v59, v6
  v_and_b32 v47, v59, v7
  v_mfma_f32_16x16x32_bf16 v[24:27], v[40:43], v[64:67], 0
  s_nop 0
  v_mfma_f32_16x16x32_bf16 v[28:31], v[44:47], v[64:67], 0
  v_perm_b32 v59, v128, v128, s73
  v_and_b32 v48, v59, v4
  v_and_b32 v49, v59, v5
  v_and_b32 v50, v59, v6
  v_and_b32 v51, v59, v7
  v_perm_b32 v59, v136, v136, s73
  v_and_b32 v52, v59, v4
  v_and_b32 v53, v59, v5
  v_and_b32 v54, v59, v6
  v_and_b32 v55, v59, v7
  v_mfma_f32_16x16x32_bf16 v[24:27], v[48:51], v[68:71], v[24:27]
  s_nop 0
  v_mfma_f32_16x16x32_bf16 v[28:31], v[52:55], v[68:71], v[28:31]
  v_perm_b32 v59, v129, v129, s72
  v_and_b32 v40, v59, v4
  v_and_b32 v41, v59, v5
  v_and_b32 v42, v59, v6
  v_and_b32 v43, v59, v7
  v_perm_b32 v59, v137, v137, s72
  v_and_b32 v44, v59, v4
  v_and_b32 v45, v59, v5
  v_and_b32 v46, v59, v6
  v_and_b32 v47, v59, v7
  v_mfma_f32_16x16x32_bf16 v[24:27], v[40:43], v[72:75], v[24:27]
  s_nop 0
  v_mfma_f32_16x16x32_bf16 v[28:31], v[44:47], v[72:75], v[28:31]
  v_perm_b32 v59, v129, v129, s73
  v_and_b32 v48, v59, v4
  v_and_b32 v49, v59, v5
  v_and_b32 v50, v59, v6
  v_and_b32 v51, v59, v7
  v_perm_b32 v59, v137, v137, s73
  v_and_b32 v52, v59, v4
  v_and_b32 v53, v59, v5
  v_and_b32 v54, v59, v6
  v_and_b32 v55, v59, v7
  v_mfma_f32_16x16x32_bf16 v[24:27], v[48:51], v[76:79], v[24:27]
  s_nop 0
  v_mfma_f32_16x16x32_bf16 v[28:31], v[52:55], v[76:79], v[28:31]
  v_perm_b32 v59, v130, v130, s72
  v_and_b32 v40, v59, v4
  v_and_b32 v41, v59, v5
  v_and_b32 v42, v59, v6
  v_and_b32 v43, v59, v7
  v_perm_b32 v59, v138, v138, s72
  v_and_b32 v44, v59, v4
  v_and_b32 v45, v59, v5
  v_and_b32 v46, v59, v6
  v_and_b32 v47, v59, v7
  v_mfma_f32_16x16x32_bf16 v[24:27], v[40:43], v[80:83], v[24:27]
  s_nop 0
  v_mfma_f32_16x16x32_bf16 v[28:31], v[44:47], v[80:83], v[28:31]
  v_perm_b32 v59, v130, v130, s73
  v_and_b32 v48, v59, v4
  v_and_b32 v49, v59, v5
  v_and_b32 v50, v59, v6
  v_and_b32 v51, v59, v7
  v_perm_b32 v59, v138, v138, s73
  v_and_b32 v52, v59, v4
  v_and_b32 v53, v59, v5
  v_and_b32 v54, v59, v6
  v_and_b32 v55, v59, v7
  v_mfma_f32_16x16x32_bf16 v[24:27], v[48:51], v[84:87], v[24:27]
  s_nop 0
  v_mfma_f32_16x16x32_bf16 v[28:31], v[52:55], v[84:87], v[28:31]
  v_perm_b32 v59, v131, v131, s72
  v_and_b32 v40, v59, v4
  v_and_b32 v41, v59, v5
  v_and_b32 v42, v59, v6
  v_and_b32 v43, v59, v7
  v_perm_b32 v59, v139, v139, s72
  v_and_b32 v44, v59, v4
  v_and_b32 v45, v59, v5
  v_and_b32 v46, v59, v6
  v_and_b32 v47, v59, v7
  v_mfma_f32_16x16x32_bf16 v[24:27], v[40:43], v[88:91], v[24:27]
  s_nop 0
  v_mfma_f32_16x16x32_bf16 v[28:31], v[44:47], v[88:91], v[28:31]
  v_perm_b32 v59, v131, v131, s73
  v_and_b32 v48, v59, v4
  v_and_b32 v49, v59, v5
  v_and_b32 v50, v59, v6
  v_and_b32 v51, v59, v7
  v_perm_b32 v59, v139, v139, s73
  v_and_b32 v52, v59, v4
  v_and_b32 v53, v59, v5
  v_and_b32 v54, v59, v6
  v_and_b32 v55, v59, v7
  v_mfma_f32_16x16x32_bf16 v[24:27], v[48:51], v[92:95], v[24:27]
  s_nop 0
  v_mfma_f32_16x16x32_bf16 v[28:31], v[52:55], v[92:95], v[28:31]
  v_perm_b32 v59, v132, v132, s72
  v_and_b32 v40, v59, v4
  v_and_b32 v41, v59, v5
  v_and_b32 v42, v59, v6
  v_and_b32 v43, v59, v7
  v_perm_b32 v59, v140, v140, s72
  v_and_b32 v44, v59, v4
  v_and_b32 v45, v59, v5
  v_and_b32 v46, v59, v6
  v_and_b32 v47, v59, v7
  v_mfma_f32_16x16x32_bf16 v[24:27], v[40:43], v[96:99], v[24:27]
  s_nop 0
  v_mfma_f32_16x16x32_bf16 v[28:31], v[44:47], v[96:99], v[28:31]
  v_perm_b32 v59, v132, v132, s73
  v_and_b32 v48, v59, v4
  v_and_b32 v49, v59, v5
  v_and_b32 v50, v59, v6
  v_and_b32 v51, v59, v7
  v_perm_b32 v59, v140, v140, s73
  v_and_b32 v52, v59, v4
  v_and_b32 v53, v59, v5
  v_and_b32 v54, v59, v6
  v_and_b32 v55, v59, v7
  v_mfma_f32_16x16x32_bf16 v[24:27], v[48:51], v[100:103], v[24:27]
  s_nop 0
  v_mfma_f32_16x16x32_bf16 v[28:31], v[52:55], v[100:103], v[28:31]
  v_perm_b32 v59, v133, v133, s72
  v_and_b32 v40, v59, v4
  v_and_b32 v41, v59, v5
  v_and_b32 v42, v59, v6
  v_and_b32 v43, v59, v7
  v_perm_b32 v59, v141, v141, s72
  v_and_b32 v44, v59, v4
  v_and_b32 v45, v59, v5
  v_and_b32 v46, v59, v6
  v_and_b32 v47, v59, v7
  v_mfma_f32_16x16x32_bf16 v[24:27], v[40:43], v[104:107], v[24:27]
  s_nop 0
  v_mfma_f32_16x16x32_bf16 v[28:31], v[44:47], v[104:107], v[28:31]
  v_perm_b32 v59, v133, v133, s73
  v_and_b32 v48, v59, v4
  v_and_b32 v49, v59, v5
  v_and_b32 v50, v59, v6
  v_and_b32 v51, v59, v7
  v_perm_b32 v59, v141, v141, s73
  v_and_b32 v52, v59, v4
  v_and_b32 v53, v59, v5
  v_and_b32 v54, v59, v6
  v_and_b32 v55, v59, v7
  v_mfma_f32_16x16x32_bf16 v[24:27], v[48:51], v[108:111], v[24:27]
  s_nop 0
  v_mfma_f32_16x16x32_bf16 v[28:31], v[52:55], v[108:111], v[28:31]
  v_perm_b32 v59, v134, v134, s72
  v_and_b32 v40, v59, v4
  v_and_b32 v41, v59, v5
  v_and_b32 v42, v59, v6
  v_and_b32 v43, v59, v7
  v_perm_b32 v59, v142, v142, s72
  v_and_b32 v44, v59, v4
  v_and_b32 v45, v59, v5
  v_and_b32 v46, v59, v6
  v_and_b32 v47, v59, v7
  v_mfma_f32_16x16x32_bf16 v[24:27], v[40:43], v[112:115], v[24:27]
  s_nop 0
  v_mfma_f32_16x16x32_bf16 v[28:31], v[44:47], v[112:115], v[28:31]
  v_perm_b32 v59, v134, v134, s73
  v_and_b32 v48, v59, v4
  v_and_b32 v49, v59, v5
  v_and_b32 v50, v59, v6
  v_and_b32 v51, v59, v7
  v_perm_b32 v59, v142, v142, s73
  v_and_b32 v52, v59, v4
  v_and_b32 v53, v59, v5
  v_and_b32 v54, v59, v6
  v_and_b32 v55, v59, v7
  v_mfma_f32_16x16x32_bf16 v[24:27], v[48:51], v[116:119], v[24:27]
  s_nop 0
  v_mfma_f32_16x16x32_bf16 v[28:31], v[52:55], v[116:119], v[28:31]
  v_perm_b32 v59, v135, v135, s72
  v_and_b32 v40, v59, v4
  v_and_b32 v41, v59, v5
  v_and_b32 v42, v59, v6
  v_and_b32 v43, v59, v7
  v_perm_b32 v59, v143, v143, s72
  v_and_b32 v44, v59, v4
  v_and_b32 v45, v59, v5
  v_and_b32 v46, v59, v6
  v_and_b32 v47, v59, v7
  v_mfma_f32_16x16x32_bf16 v[24:27], v[40:43], v[120:123], v[24:27]
  s_nop 0
  v_mfma_f32_16x16x32_bf16 v[28:31], v[44:47], v[120:123], v[28:31]
  v_perm_b32 v59, v135, v135, s73
  v_and_b32 v48, v59, v4
  v_and_b32 v49, v59, v5
  v_and_b32 v50, v59, v6
  v_and_b32 v51, v59, v7
  v_perm_b32 v59, v143, v143, s73
  v_and_b32 v52, v59, v4
  v_and_b32 v53, v59, v5
  v_and_b32 v54, v59, v6
  v_and_b32 v55, v59, v7
  v_mfma_f32_16x16x32_bf16 v[24:27], v[48:51], v[124:127], v[24:27]
  s_nop 0
  v_mfma_f32_16x16x32_bf16 v[28:31], v[52:55], v[124:127], v[28:31]
  v_lshrrev_b32 v57, 1, v12
  v_lshl_add_u32 v57, v57, 11, v60
  s_lshl_b32 s4, s2, 13
  s_lshl_b32 s5, s74, 9
  s_add_u32 s4, s4, s5
  s_add_u32 s5, s4, 4096
  buffer_store_dwordx4 v[24:27], v57, s[8:11], s4 offen sc1
  s_nop 0
  buffer_store_dwordx4 v[28:31], v57, s[8:11], s5 offen sc1
L_wo:
  v_lshlrev_b32 v57, 13, v12
  v_lshl_add_u32 v57, v11, 4, v57
  s_lshl_b32 s4, s64, 17
  s_lshl_b32 s5, s74, 8
  s_add_u32 s4, s4, s5
  buffer_load_dwordx4 v[128:131], v57, s[20:23], s4 offen offset:0
  buffer_load_dwordx4 v[132:135], v57, s[20:23], s4 offen offset:1024
  s_waitcnt vmcnt(1)
  buffer_load_dwordx4 v[136:139], v57, s[20:23], s4 offen offset:2048
  s_waitcnt vmcnt(1)
  buffer_load_dwordx4 v[140:143], v57, s[20:23], s4 offen offset:3072
  s_add_u32 s4, s4, 4096
  s_waitcnt vmcnt(1)
  buffer_load_dwordx4 v[144:147], v57, s[20:23], s4 offen offset:0
  s_waitcnt vmcnt(1)
  buffer_load_dwordx4 v[148:151], v57, s[20:23], s4 offen offset:1024
  s_waitcnt vmcnt(1)
  buffer_load_dwordx4 v[152:155], v57, s[20:23], s4 offen offset:2048
  s_waitcnt vmcnt(1)
  buffer_load_dwordx4 v[156:159], v57, s[20:23], s4 offen offset:3072
  s_add_u32 s4, s4, 28672
  s_waitcnt vmcnt(1)
  buffer_load_dwordx4 v[160:163], v57, s[20:23], s4 offen offset:0
  s_waitcnt vmcnt(1)
  buffer_load_dwordx4 v[164:167], v57, s[20:23], s4 offen offset:1024
  s_waitcnt vmcnt(1)
  buffer_load_dwordx4 v[168:171], v57, s[20:23], s4 offen offset:2048
  s_waitcnt vmcnt(1)
  buffer_load_dwordx4 v[172:175], v57, s[20:23], s4 offen offset:3072
  s_add_u32 s4, s4, 4096
  s_waitcnt vmcnt(1)
  buffer_load_dwordx4 v[176:179], v57, s[20:23], s4 offen offset:0
  s_waitcnt vmcnt(1)
  buffer_load_dwordx4 v[180:183], v57, s[20:23], s4 offen offset:1024
  s_waitcnt vmcnt(1)
  buffer_load_dwordx4 v[184:187], v57, s[20:23], s4 offen offset:2048
  s_waitcnt vmcnt(1)
  buffer_load_dwordx4 v[188:191], v57, s[20:23], s4 offen offset:3072
  s_add_u32 s4, s4, 28672
  s_waitcnt vmcnt(1)
  buffer_load_dwordx4 v[192:195], v57, s[20:23], s4 offen offset:0
  s_waitcnt vmcnt(1)
  buffer_load_dwordx4 v[196:199], v57, s[20:23], s4 offen offset:1024
  s_waitcnt vmcnt(1)
  buffer_load_dwordx4 v[200:203], v57, s[20:23], s4 offen offset:2048
  s_waitcnt vmcnt(1)
  buffer_load_dwordx4 v[204:207], v57, s[20:23], s4 offen offset:3072
  s_add_u32 s4, s4, 4096
  s_waitcnt vmcnt(1)
  buffer_load_dwordx4 v[208:211], v57, s[20:23], s4 offen offset:0
  s_waitcnt vmcnt(1)
  buffer_load_dwordx4 v[212:215], v57, s[20:23], s4 offen offset:1024
  s_waitcnt vmcnt(1)
  buffer_load_dwordx4 v[216:219], v57, s[20:23], s4 offen offset:2048
  s_waitcnt vmcnt(1)
  buffer_load_dwordx4 v[220:223], v57, s[20:23], s4 offen offset:3072
  s_add_u32 s4, s4, 28672
  s_waitcnt vmcnt(1)
  buffer_load_dwordx4 v[224:227], v57, s[20:23], s4 offen offset:0
  s_waitcnt vmcnt(1)
  buffer_load_dwordx4 v[228:231], v57, s[20:23], s4 offen offset:1024
  s_waitcnt vmcnt(1)
  buffer_load_dwordx4 v[232:235], v57, s[20:23], s4 offen offset:2048
  s_waitcnt vmcnt(1)
  buffer_load_dwordx4 v[236:239], v57, s[20:23], s4 offen offset:3072
  s_add_u32 s4, s4, 4096
  s_waitcnt vmcnt(1)
  buffer_load_dwordx4 v[240:243], v57, s[20:23], s4 offen offset:0
  s_waitcnt vmcnt(1)
  buffer_load_dwordx4 v[244:247], v57, s[20:23], s4 offen offset:1024
  s_waitcnt vmcnt(1)
  buffer_load_dwordx4 v[248:251], v57, s[20:23], s4 offen offset:2048
  s_waitcnt vmcnt(1)
  buffer_load_dwordx4 v[252:255], v57, s[20:23], s4 offen offset:3072
  s_add_u32 s4, s4, 28672
  s_mov_b32 s72, 0x05040100
  s_mov_b32 s73, 0x07060302
  s_mul_i32 s5, s66, 2048
  s_lshl_b32 s4, s66, 3
  s_add_u32 s4, s4, 524288
  s_lshl_b32 s6, s74, 9
  s_add_u32 s5, s5, s6
  v_lshlrev_b32 v61, 4, v11
  v_and_b32 v57, 3, v11
  v_mul_u32_u24 v57, 272, v57
  v_lshl_add_u32 v57, v12, 4, v57
  v_mov_b32 v58, 0
  s_mov_b32 s6, 0xfffffffe
  s_waitcnt vmcnt(0)
  v_perm_b32 v96, v132, v128, s72
  v_perm_b32 v97, v140, v136, s72
  v_perm_b32 v98, v148, v144, s72
  v_perm_b32 v99, v156, v152, s72
  v_perm_b32 v100, v132, v128, s73
  v_perm_b32 v101, v140, v136, s73
  v_perm_b32 v102, v148, v144, s73
  v_perm_b32 v103, v156, v152, s73
  v_perm_b32 v104, v133, v129, s72
  v_perm_b32 v105, v141, v137, s72
  v_perm_b32 v106, v149, v145, s72
  v_perm_b32 v107, v157, v153, s72
  v_perm_b32 v108, v133, v129, s73
  v_perm_b32 v109, v141, v137, s73
  v_perm_b32 v110, v149, v145, s73
  v_perm_b32 v111, v157, v153, s73
  v_perm_b32 v112, v134, v130, s72
  v_perm_b32 v113, v142, v138, s72
  v_perm_b32 v114, v150, v146, s72
  v_perm_b32 v115, v158, v154, s72
  v_perm_b32 v116, v134, v130, s73
  v_perm_b32 v117, v142, v138, s73
  v_perm_b32 v118, v150, v146, s73
  v_perm_b32 v119, v158, v154, s73
  v_perm_b32 v120, v135, v131, s72
  v_perm_b32 v121, v143, v139, s72
  v_perm_b32 v122, v151, v147, s72
  v_perm_b32 v123, v159, v155, s72
  v_perm_b32 v124, v135, v131, s73
  v_perm_b32 v125, v143, v139, s73
  v_perm_b32 v126, v151, v147, s73
  v_perm_b32 v127, v159, v155, s73
  v_perm_b32 v128, v164, v160, s72
  v_perm_b32 v129, v172, v168, s72
  v_perm_b32 v130, v180, v176, s72
  v_perm_b32 v131, v188, v184, s72
  v_perm_b32 v132, v164, v160, s73
  v_perm_b32 v133, v172, v168, s73
  v_perm_b32 v134, v180, v176, s73
  v_perm_b32 v135, v188, v184, s73
  v_perm_b32 v136, v165, v161, s72
  v_perm_b32 v137, v173, v169, s72
  v_perm_b32 v138, v181, v177, s72
  v_perm_b32 v139, v189, v185, s72
  v_perm_b32 v140, v165, v161, s73
  v_perm_b32 v141, v173, v169, s73
  v_perm_b32 v142, v181, v177, s73
  v_perm_b32 v143, v189, v185, s73
  v_perm_b32 v144, v166, v162, s72
  v_perm_b32 v145, v174, v170, s72
  v_perm_b32 v146, v182, v178, s72
  v_perm_b32 v147, v190, v186, s72
  v_perm_b32 v148, v166, v162, s73
  v_perm_b32 v149, v174, v170, s73
  v_perm_b32 v150, v182, v178, s73
  v_perm_b32 v151, v190, v186, s73
  v_perm_b32 v152, v167, v163, s72
  v_perm_b32 v153, v175, v171, s72
  v_perm_b32 v154, v183, v179, s72
  v_perm_b32 v155, v191, v187, s72
  v_perm_b32 v156, v167, v163, s73
  v_perm_b32 v157, v175, v171, s73
  v_perm_b32 v158, v183, v179, s73
  v_perm_b32 v159, v191, v187, s73
  v_perm_b32 v160, v196, v192, s72
  v_perm_b32 v161, v204, v200, s72
  v_perm_b32 v162, v212, v208, s72
  v_perm_b32 v163, v220, v216, s72
  v_perm_b32 v164, v196, v192, s73
  v_perm_b32 v165, v204, v200, s73
  v_perm_b32 v166, v212, v208, s73
  v_perm_b32 v167, v220, v216, s73
  v_perm_b32 v168, v197, v193, s72
  v_perm_b32 v169, v205, v201, s72
  v_perm_b32 v170, v213, v209, s72
  v_perm_b32 v171, v221, v217, s72
  v_perm_b32 v172, v197, v193, s73
  v_perm_b32 v173, v205, v201, s73
  v_perm_b32 v174, v213, v209, s73
  v_perm_b32 v175, v221, v217, s73
  v_perm_b32 v176, v198, v194, s72
  v_perm_b32 v177, v206, v202, s72
  v_perm_b32 v178, v214, v210, s72
  v_perm_b32 v179, v222, v218, s72
  v_perm_b32 v180, v198, v194, s73
  v_perm_b32 v181, v206, v202, s73
  v_perm_b32 v182, v214, v210, s73
  v_perm_b32 v183, v222, v218, s73
  v_perm_b32 v184, v199, v195, s72
  v_perm_b32 v185, v207, v203, s72
  v_perm_b32 v186, v215, v211, s72
  v_perm_b32 v187, v223, v219, s72
  v_perm_b32 v188, v199, v195, s73
  v_perm_b32 v189, v207, v203, s73
  v_perm_b32 v190, v215, v211, s73
  v_perm_b32 v191, v223, v219, s73
  v_perm_b32 v192, v228, v224, s72
  v_perm_b32 v193, v236, v232, s72
  v_perm_b32 v194, v244, v240, s72
  v_perm_b32 v195, v252, v248, s72
  v_perm_b32 v196, v228, v224, s73
  v_perm_b32 v197, v236, v232, s73
  v_perm_b32 v198, v244, v240, s73
  v_perm_b32 v199, v252, v248, s73
  v_perm_b32 v200, v229, v225, s72
  v_perm_b32 v201, v237, v233, s72
  v_perm_b32 v202, v245, v241, s72
  v_perm_b32 v203, v253, v249, s72
  v_perm_b32 v204, v229, v225, s73
  v_perm_b32 v205, v237, v233, s73
  v_perm_b32 v206, v245, v241, s73
  v_perm_b32 v207, v253, v249, s73
  v_perm_b32 v208, v230, v226, s72
  v_perm_b32 v209, v238, v234, s72
  v_perm_b32 v210, v246, v242, s72
  v_perm_b32 v211, v254, v250, s72
  v_perm_b32 v212, v230, v226, s73
  v_perm_b32 v213, v238, v234, s73
  v_perm_b32 v214, v246, v242, s73
  v_perm_b32 v215, v254, v250, s73
  v_perm_b32 v216, v231, v227, s72
  v_perm_b32 v217, v239, v235, s72
  v_perm_b32 v218, v247, v243, s72
  v_perm_b32 v219, v255, v251, s72
  v_perm_b32 v220, v231, v227, s73
  v_perm_b32 v221, v239, v235, s73
  v_perm_b32 v222, v247, v243, s73
  v_perm_b32 v223, v255, v251, s73
  v_lshlrev_b32 v59, 4, v1
  s_barrier
  s_cmp_lg_u32 s74, 2
  s_cbranch_scc1 L_nolb
  s_mov_b32 s28, s56
  s_mov_b32 s29, s57
  s_mov_b32 s30, 256
  s_mov_b32 s31, 0x00020000
  v_lshlrev_b32 v64, 2, v1
  v_mov_b32 v65, 0
  s_mov_b64 exec, 0xff
  buffer_load_dword v65, v64, s[28:31], 0 offen offset:16 sc1
  s_mov_b64 exec, -1
  ds_read_b32 v66, v58 offset:22544
  s_waitcnt vmcnt(0) lgkmcnt(0)
  v_sub_u32 v66, v66, v65
  v_cvt_f32_i32 v66, v66
  v_cmp_ne_u32 vcc, 0, v65
  s_nop 1
  v_cndmask_b32 v66, 0, v66, vcc
  v_cndmask_b32 v67, 0, 1.0, vcc
  s_nop 0
  v_add_f32_dpp v66, v66, v66 row_ror:1 row_mask:0xf bank_mask:0xf
  v_add_f32_dpp v67, v67, v67 row_ror:1 row_mask:0xf bank_mask:0xf
  s_nop 0
  v_add_f32_dpp v66, v66, v66 row_ror:2 row_mask:0xf bank_mask:0xf
  v_add_f32_dpp v67, v67, v67 row_ror:2 row_mask:0xf bank_mask:0xf
  s_nop 0
  v_add_f32_dpp v66, v66, v66 row_ror:4 row_mask:0xf bank_mask:0xf
  v_add_f32_dpp v67, v67, v67 row_ror:4 row_mask:0xf bank_mask:0xf
  s_nop 0
  v_add_f32_dpp v66, v66, v66 row_ror:8 row_mask:0xf bank_mask:0xf
  v_add_f32_dpp v67, v67, v67 row_ror:8 row_mask:0xf bank_mask:0xf
  v_max_f32 v67, 1.0, v67
  v_rcp_f32 v67, v67
  s_nop 0
  v_mul_f32 v66, v66, v67
  v_add_f32 v66, 0xc1f00000, v66
  v_mul_f32 v66, 0x3cb60b61, v66
  v_max_f32 v66, 0, v66
  v_min_f32 v66, 0x40e00000, v66
  v_cvt_u32_f32 v66, v66
  s_mov_b64 exec, 1
  ds_write_b32 v58, v66 offset:22604
  s_mov_b64 exec, -1
  s_waitcnt lgkmcnt(0)
L_nolb:
  ds_read_b128 v[64:67], v58 offset:22528
  ds_read_b128 v[16:19], v59 offset:32768
  ds_read_b128 v[20:23], v59 offset:33792
  ds_read_b128 v[24:27], v59 offset:34816
  ds_read_b128 v[28:31], v59 offset:35840
  ds_read_b128 v[32:35], v59 offset:36864
  ds_read_b128 v[36:39], v59 offset:37888
  ds_read_b128 v[40:43], v59 offset:38912
  ds_read_b128 v[44:47], v59 offset:39936
  s_waitcnt lgkmcnt(8)
  v_max3_f32 v10, v64, v65, v66
  v_max_f32 v10, v10, v67
  v_mov_b32 v68, 0
  v_mov_b32 v69, 0
  v_mov_b32 v70, 0
  v_mov_b32 v71, 0
  s_waitcnt lgkmcnt(0)
  v_sub_f32 v16, v16, v10
  v_sub_f32 v17, v17, v10
  v_sub_f32 v18, v18, v10
  v_sub_f32 v19, v19, v10
  v_sub_f32 v20, v20, v10
  v_sub_f32 v21, v21, v10
  v_sub_f32 v22, v22, v10
  v_sub_f32 v23, v23, v10
  v_sub_f32 v24, v24, v10
  v_sub_f32 v25, v25, v10
  v_sub_f32 v26, v26, v10
  v_sub_f32 v27, v27, v10
  v_sub_f32 v28, v28, v10
  v_sub_f32 v29, v29, v10
  v_sub_f32 v30, v30, v10
  v_sub_f32 v31, v31, v10
  v_sub_f32 v32, v32, v10
  v_sub_f32 v33, v33, v10
  v_sub_f32 v34, v34, v10
  v_sub_f32 v35, v35, v10
  v_sub_f32 v36, v36, v10
  v_sub_f32 v37, v37, v10
  v_sub_f32 v38, v38, v10
  v_sub_f32 v39, v39, v10
  v_sub_f32 v40, v40, v10
  v_sub_f32 v41, v41, v10
  v_sub_f32 v42, v42, v10
  v_sub_f32 v43, v43, v10
  v_sub_f32 v44, v44, v10
  v_sub_f32 v45, v45, v10
  v_sub_f32 v46, v46, v10
  v_sub_f32 v47, v47, v10
  v_mul_f32 v16, s70, v16
  v_mul_f32 v17, s70, v17
  v_mul_f32 v18, s70, v18
  v_mul_f32 v19, s70, v19
  v_mul_f32 v20, s70, v20
  v_mul_f32 v21, s70, v21
  v_mul_f32 v22, s70, v22
  v_mul_f32 v23, s70, v23
  v_mul_f32 v24, s70, v24
  v_mul_f32 v25, s70, v25
  v_mul_f32 v26, s70, v26
  v_mul_f32 v27, s70, v27
  v_mul_f32 v28, s70, v28
  v_mul_f32 v29, s70, v29
  v_mul_f32 v30, s70, v30
  v_mul_f32 v31, s70, v31
  v_mul_f32 v32, s70, v32
  v_mul_f32 v33, s70, v33
  v_mul_f32 v34, s70, v34
  v_mul_f32 v35, s70, v35
  v_mul_f32 v36, s70, v36
  v_mul_f32 v37, s70, v37
  v_mul_f32 v38, s70, v38
  v_mul_f32 v39, s70, v39
  v_mul_f32 v40, s70, v40
  v_mul_f32 v41, s70, v41
  v_mul_f32 v42, s70, v42
  v_mul_f32 v43, s70, v43
  v_mul_f32 v44, s70, v44
  v_mul_f32 v45, s70, v45
  v_mul_f32 v46, s70, v46
  v_mul_f32 v47, s70, v47
  v_exp_f32 v16, v16
  v_exp_f32 v17, v17
  v_exp_f32 v18, v18
  v_exp_f32 v19, v19
  v_exp_f32 v20, v20
  v_exp_f32 v21, v21
  v_exp_f32 v22, v22
  v_exp_f32 v23, v23
  v_exp_f32 v24, v24
  v_exp_f32 v25, v25
  v_exp_f32 v26, v26
  v_exp_f32 v27, v27
  v_exp_f32 v28, v28
  v_exp_f32 v29, v29
  v_exp_f32 v30, v30
  v_exp_f32 v31, v31
  v_exp_f32 v32, v32
  v_exp_f32 v33, v33
  v_exp_f32 v34, v34
  v_exp_f32 v35, v35
  v_exp_f32 v36, v36
  v_exp_f32 v37, v37
  v_exp_f32 v38, v38
  v_exp_f32 v39, v39
  v_exp_f32 v40, v40
  v_exp_f32 v41, v41
  v_exp_f32 v42, v42
  v_exp_f32 v43, v43
  v_exp_f32 v44, v44
  v_exp_f32 v45, v45
  v_exp_f32 v46, v46
  v_exp_f32 v47, v47
  v_add_f32 v68, v68, v16
  v_add_f32 v69, v69, v17
  v_add_f32 v70, v70, v18
  v_add_f32 v71, v71, v19
  v_add_f32 v68, v68, v20
  v_add_f32 v69, v69, v21
  v_add_f32 v70, v70, v22
  v_add_f32 v71, v71, v23
  v_add_f32 v68, v68, v24
  v_add_f32 v69, v69, v25
  v_add_f32 v70, v70, v26
  v_add_f32 v71, v71, v27
  v_add_f32 v68, v68, v28
  v_add_f32 v69, v69, v29
  v_add_f32 v70, v70, v30
  v_add_f32 v71, v71, v31
  v_add_f32 v68, v68, v32
  v_add_f32 v69, v69, v33
  v_add_f32 v70, v70, v34
  v_add_f32 v71, v71, v35
  v_add_f32 v68, v68, v36
  v_add_f32 v69, v69, v37
  v_add_f32 v70, v70, v38
  v_add_f32 v71, v71, v39
  v_add_f32 v68, v68, v40
  v_add_f32 v69, v69, v41
  v_add_f32 v70, v70, v42
  v_add_f32 v71, v71, v43
  v_add_f32 v68, v68, v44
  v_add_f32 v69, v69, v45
  v_add_f32 v70, v70, v46
  v_add_f32 v71, v71, v47
  ds_read_b128 v[16:19], v59 offset:40960
  ds_read_b128 v[20:23], v59 offset:41984
  ds_read_b128 v[24:27], v59 offset:43008
  ds_read_b128 v[28:31], v59 offset:44032
  ds_read_b128 v[32:35], v59 offset:45056
  ds_read_b128 v[36:39], v59 offset:46080
  ds_read_b128 v[40:43], v59 offset:47104
  ds_read_b128 v[44:47], v59 offset:48128
  s_waitcnt lgkmcnt(0)
  v_sub_f32 v16, v16, v10
  v_sub_f32 v17, v17, v10
  v_sub_f32 v18, v18, v10
  v_sub_f32 v19, v19, v10
  v_sub_f32 v20, v20, v10
  v_sub_f32 v21, v21, v10
  v_sub_f32 v22, v22, v10
  v_sub_f32 v23, v23, v10
  v_sub_f32 v24, v24, v10
  v_sub_f32 v25, v25, v10
  v_sub_f32 v26, v26, v10
  v_sub_f32 v27, v27, v10
  v_sub_f32 v28, v28, v10
  v_sub_f32 v29, v29, v10
  v_sub_f32 v30, v30, v10
  v_sub_f32 v31, v31, v10
  v_sub_f32 v32, v32, v10
  v_sub_f32 v33, v33, v10
  v_sub_f32 v34, v34, v10
  v_sub_f32 v35, v35, v10
  v_sub_f32 v36, v36, v10
  v_sub_f32 v37, v37, v10
  v_sub_f32 v38, v38, v10
  v_sub_f32 v39, v39, v10
  v_sub_f32 v40, v40, v10
  v_sub_f32 v41, v41, v10
  v_sub_f32 v42, v42, v10
  v_sub_f32 v43, v43, v10
  v_sub_f32 v44, v44, v10
  v_sub_f32 v45, v45, v10
  v_sub_f32 v46, v46, v10
  v_sub_f32 v47, v47, v10
  v_mul_f32 v16, s70, v16
  v_mul_f32 v17, s70, v17
  v_mul_f32 v18, s70, v18
  v_mul_f32 v19, s70, v19
  v_mul_f32 v20, s70, v20
  v_mul_f32 v21, s70, v21
  v_mul_f32 v22, s70, v22
  v_mul_f32 v23, s70, v23
  v_mul_f32 v24, s70, v24
  v_mul_f32 v25, s70, v25
  v_mul_f32 v26, s70, v26
  v_mul_f32 v27, s70, v27
  v_mul_f32 v28, s70, v28
  v_mul_f32 v29, s70, v29
  v_mul_f32 v30, s70, v30
  v_mul_f32 v31, s70, v31
  v_mul_f32 v32, s70, v32
  v_mul_f32 v33, s70, v33
  v_mul_f32 v34, s70, v34
  v_mul_f32 v35, s70, v35
  v_mul_f32 v36, s70, v36
  v_mul_f32 v37, s70, v37
  v_mul_f32 v38, s70, v38
  v_mul_f32 v39, s70, v39
  v_mul_f32 v40, s70, v40
  v_mul_f32 v41, s70, v41
  v_mul_f32 v42, s70, v42
  v_mul_f32 v43, s70, v43
  v_mul_f32 v44, s70, v44
  v_mul_f32 v45, s70, v45
  v_mul_f32 v46, s70, v46
  v_mul_f32 v47, s70, v47
  v_exp_f32 v16, v16
  v_exp_f32 v17, v17
  v_exp_f32 v18, v18
  v_exp_f32 v19, v19
  v_exp_f32 v20, v20
  v_exp_f32 v21, v21
  v_exp_f32 v22, v22
  v_exp_f32 v23, v23
  v_exp_f32 v24, v24
  v_exp_f32 v25, v25
  v_exp_f32 v26, v26
  v_exp_f32 v27, v27
  v_exp_f32 v28, v28
  v_exp_f32 v29, v29
  v_exp_f32 v30, v30
  v_exp_f32 v31, v31
  v_exp_f32 v32, v32
  v_exp_f32 v33, v33
  v_exp_f32 v34, v34
  v_exp_f32 v35, v35
  v_exp_f32 v36, v36
  v_exp_f32 v37, v37
  v_exp_f32 v38, v38
  v_exp_f32 v39, v39
  v_exp_f32 v40, v40
  v_exp_f32 v41, v41
  v_exp_f32 v42, v42
  v_exp_f32 v43, v43
  v_exp_f32 v44, v44
  v_exp_f32 v45, v45
  v_exp_f32 v46, v46
  v_exp_f32 v47, v47
  v_add_f32 v68, v68, v16
  v_add_f32 v69, v69, v17
  v_add_f32 v70, v70, v18
  v_add_f32 v71, v71, v19
  v_add_f32 v68, v68, v20
  v_add_f32 v69, v69, v21
  v_add_f32 v70, v70, v22
  v_add_f32 v71, v71, v23
  v_add_f32 v68, v68, v24
  v_add_f32 v69, v69, v25
  v_add_f32 v70, v70, v26
  v_add_f32 v71, v71, v27
  v_add_f32 v68, v68, v28
  v_add_f32 v69, v69, v29
  v_add_f32 v70, v70, v30
  v_add_f32 v71, v71, v31
  v_add_f32 v68, v68, v32
  v_add_f32 v69, v69, v33
  v_add_f32 v70, v70, v34
  v_add_f32 v71, v71, v35
  v_add_f32 v68, v68, v36
  v_add_f32 v69, v69, v37
  v_add_f32 v70, v70, v38
  v_add_f32 v71, v71, v39
  v_add_f32 v68, v68, v40
  v_add_f32 v69, v69, v41
  v_add_f32 v70, v70, v42
  v_add_f32 v71, v71, v43
  v_add_f32 v68, v68, v44
  v_add_f32 v69, v69, v45
  v_add_f32 v70, v70, v46
  v_add_f32 v71, v71, v47
  v_add_f32 v68, v68, v69
  v_add_f32 v70, v70, v71
  v_add_f32 v11, v68, v70
  s_nop 1
  v_add_f32_dpp v11, v11, v11 row_ror:1 row_mask:0xf bank_mask:0xf
  s_nop 1
  v_add_f32_dpp v11, v11, v11 row_ror:2 row_mask:0xf bank_mask:0xf
  s_nop 1
  v_add_f32_dpp v11, v11, v11 row_ror:4 row_mask:0xf bank_mask:0xf
  s_nop 1
  v_add_f32_dpp v11, v11, v11 row_ror:8 row_mask:0xf bank_mask:0xf
  v_mov_b32 v13, v11
  s_nop 1
  v_permlane16_swap_b32 v13, v11
  v_add_f32 v11, v13, v11
  v_mov_b32 v13, v11
  s_nop 1
  v_permlane32_swap_b32 v13, v11
  v_add_f32 v11, v13, v11
  v_rcp_f32 v14, v11
  v_sub_f32 v64, v64, v10
  v_sub_f32 v65, v65, v10
  v_sub_f32 v66, v66, v10
  v_sub_f32 v67, v67, v10
  v_mul_f32 v64, s70, v64
  v_mul_f32 v65, s70, v65
  v_mul_f32 v66, s70, v66
  v_mul_f32 v67, s70, v67
  v_exp_f32 v64, v64
  v_exp_f32 v65, v65
  v_exp_f32 v66, v66
  v_exp_f32 v67, v67
  v_mul_f32 v64, v64, v14
  v_mul_f32 v65, v65, v14
  v_mul_f32 v66, v66, v14
  v_mul_f32 v67, v67, v14
  s_cmp_lg_u32 s74, 1
  s_cbranch_scc1 L_noml
  s_mov_b64 exec, 1
  buffer_store_dwordx2 v[10:11], v58, s[60:63], s4 offen sc1
  s_mov_b64 exec, -1
  s_waitcnt vmcnt(0)
L_noml:
  s_barrier
  s_barrier
  ds_read_b128 v[16:19], v57 offset:20480
  ds_read_b128 v[20:23], v57 offset:20544
  ds_read_b128 v[24:27], v57 offset:20608
  ds_read_b128 v[28:31], v57 offset:20672
  s_waitcnt lgkmcnt(3)
  v_mfma_f32_16x16x32_bf16 v[224:227], v[16:19], v[96:99], 0
  s_waitcnt lgkmcnt(2)
  v_mfma_f32_16x16x32_bf16 v[224:227], v[20:23], v[128:131], v[224:227]
  s_waitcnt lgkmcnt(1)
  v_mfma_f32_16x16x32_bf16 v[224:227], v[24:27], v[160:163], v[224:227]
  s_waitcnt lgkmcnt(0)
  v_mfma_f32_16x16x32_bf16 v[224:227], v[28:31], v[192:195], v[224:227]
  v_mfma_f32_16x16x32_bf16 v[228:231], v[16:19], v[100:103], 0
  v_mfma_f32_16x16x32_bf16 v[228:231], v[20:23], v[132:135], v[228:231]
  v_mfma_f32_16x16x32_bf16 v[228:231], v[24:27], v[164:167], v[228:231]
  v_mfma_f32_16x16x32_bf16 v[228:231], v[28:31], v[196:199], v[228:231]
  v_mfma_f32_16x16x32_bf16 v[232:235], v[16:19], v[104:107], 0
  v_mfma_f32_16x16x32_bf16 v[232:235], v[20:23], v[136:139], v[232:235]
  v_mfma_f32_16x16x32_bf16 v[232:235], v[24:27], v[168:171], v[232:235]
  v_mfma_f32_16x16x32_bf16 v[232:235], v[28:31], v[200:203], v[232:235]
  v_mfma_f32_16x16x32_bf16 v[236:239], v[16:19], v[108:111], 0
  v_mul_f32 v72, v64, v224
  v_fmac_f32 v72, v65, v225
  v_mfma_f32_16x16x32_bf16 v[236:239], v[20:23], v[140:143], v[236:239]
  v_fmac_f32 v72, v66, v226
  v_fmac_f32 v72, v67, v227
  v_mfma_f32_16x16x32_bf16 v[236:239], v[24:27], v[172:175], v[236:239]
  v_min_u32 v72, s6, v72
  v_mfma_f32_16x16x32_bf16 v[236:239], v[28:31], v[204:207], v[236:239]
  v_mfma_f32_16x16x32_bf16 v[240:243], v[16:19], v[112:115], 0
  v_mul_f32 v73, v64, v228
  v_fmac_f32 v73, v65, v229
  v_mfma_f32_16x16x32_bf16 v[240:243], v[20:23], v[144:147], v[240:243]
  v_fmac_f32 v73, v66, v230
  v_fmac_f32 v73, v67, v231
  v_mfma_f32_16x16x32_bf16 v[240:243], v[24:27], v[176:179], v[240:243]
  v_min_u32 v73, s6, v73
  v_mfma_f32_16x16x32_bf16 v[240:243], v[28:31], v[208:211], v[240:243]
  v_mfma_f32_16x16x32_bf16 v[244:247], v[16:19], v[116:119], 0
  v_mul_f32 v74, v64, v232
  v_fmac_f32 v74, v65, v233
  v_mfma_f32_16x16x32_bf16 v[244:247], v[20:23], v[148:151], v[244:247]
  v_fmac_f32 v74, v66, v234
  v_fmac_f32 v74, v67, v235
  v_mfma_f32_16x16x32_bf16 v[244:247], v[24:27], v[180:183], v[244:247]
  v_min_u32 v74, s6, v74
  v_mfma_f32_16x16x32_bf16 v[244:247], v[28:31], v[212:215], v[244:247]
  v_mfma_f32_16x16x32_bf16 v[248:251], v[16:19], v[120:123], 0
  v_mul_f32 v75, v64, v236
  v_fmac_f32 v75, v65, v237
  v_mfma_f32_16x16x32_bf16 v[248:251], v[20:23], v[152:155], v[248:251]
  v_fmac_f32 v75, v66, v238
  v_fmac_f32 v75, v67, v239
  v_mfma_f32_16x16x32_bf16 v[248:251], v[24:27], v[184:187], v[248:251]
  v_min_u32 v75, s6, v75
  s_mov_b64 exec, 0xffff
  buffer_store_dwordx4 v[72:75], v61, s[60:63], s5 offen offset:0 sc1
  s_mov_b64 exec, -1
  v_mfma_f32_16x16x32_bf16 v[248:251], v[28:31], v[216:219], v[248:251]
  v_mfma_f32_16x16x32_bf16 v[252:255], v[16:19], v[124:127], 0
  v_mul_f32 v76, v64, v240
  v_fmac_f32 v76, v65, v241
  v_mfma_f32_16x16x32_bf16 v[252:255], v[20:23], v[156:159], v[252:255]
  v_fmac_f32 v76, v66, v242
  v_fmac_f32 v76, v67, v243
  v_mfma_f32_16x16x32_bf16 v[252:255], v[24:27], v[188:191], v[252:255]
  v_min_u32 v76, s6, v76
  v_mfma_f32_16x16x32_bf16 v[252:255], v[28:31], v[220:223], v[252:255]
  v_mul_f32 v77, v64, v244
  v_fmac_f32 v77, v65, v245
  v_fmac_f32 v77, v66, v246
  v_fmac_f32 v77, v67, v247
  v_min_u32 v77, s6, v77
  v_mul_f32 v78, v64, v248
  v_fmac_f32 v78, v65, v249
  v_fmac_f32 v78, v66, v250
  v_fmac_f32 v78, v67, v251
  v_min_u32 v78, s6, v78
  v_mul_f32 v79, v64, v252
  v_fmac_f32 v79, v65, v253
  v_fmac_f32 v79, v66, v254
  v_fmac_f32 v79, v67, v255
  v_min_u32 v79, s6, v79
  s_mov_b64 exec, 0xffff
  buffer_store_dwordx4 v[76:79], v61, s[60:63], s5 offen offset:256 sc1
  s_mov_b64 exec, -1
L_end:
  s_endpgm
.section .rodata,"a"
.p2align 6
.amdhsa_kernel recurrent_scan__mha_block_cached__swiglu_ffn__decode_kernel
  .amdhsa_next_free_vgpr 256
  .amdhsa_next_free_sgpr 102
  .amdhsa_accum_offset 256
  .amdhsa_group_segment_fixed_size 0
  .amdhsa_kernarg_size 96
  .amdhsa_user_sgpr_count 2
  .amdhsa_user_sgpr_kernarg_segment_ptr 1
  .amdhsa_system_sgpr_workgroup_id_x 1
.end_amdhsa_kernel
```
